```python
import torch

def _softmax(x, axis=-1):
    return torch.softmax(x, dim=axis)
def _gelu(x):
    return torch.nn.functional.gelu(x, approximate="tanh")
def _silu(x):
    return torch.nn.functional.silu(x)
def _sigmoid(x):
    return torch.sigmoid(x)
def _layernorm(x, axis=-1, eps=1e-5):
    m = x.mean(dim=axis, keepdim=True)
    v = x.var(dim=axis, keepdim=True, unbiased=False)
    return (x - m) / torch.sqrt(v + eps)
def _scatter_add(tgt, idx, src, axis=0):
    return tgt.clone().index_add_(axis, idx, src)
def _segment_sum(src, seg, n):
    out = torch.zeros((n,) + src.shape[1:], dtype=src.dtype)
    return out.index_add_(0, seg, src)
def _pad(x, pw):
    flat = tuple(v for pair in reversed(pw) for v in pair)
    return torch.nn.functional.pad(x, flat)

kernel_name = 'gated_mix__sliding_local_dilated__mixer_token_mlp__prompt'

def setup_inputs():

    _w = (lambda a: (lambda t: t.to(torch.bfloat16) if t.is_floating_point() else t)(torch.as_tensor(a)))
    def _A_setup():
        B, S, D = 1, 2048, 640
        return {
            "x": _w((lambda *s: torch.randn(*s, dtype=torch.bfloat16) * 0.05)(B, S, D)),
            "wqkv": _w((lambda *s: torch.randn(*s, dtype=torch.bfloat16) * 0.8)(D, 3 * D)),
            "wo": _w((lambda *s: torch.randn(*s, dtype=torch.bfloat16) * 0.05)(D, D)),
        }
    _A_in = _A_setup()

    def _B_setup():
        B, S, D, F = 1, 2048, 640, 1536
        return {
            "x": _w((lambda *s: torch.randn(*s, dtype=torch.bfloat16) * 0.05)(B, S, D)),
            "w1": _w((lambda *s: torch.randn(*s, dtype=torch.bfloat16) * 0.8)(S, F) * (S ** -0.5)),
            "b1": _w((lambda *s: torch.randn(*s, dtype=torch.bfloat16) * 0.8)(F) * 0.02),
            "w2": _w((lambda *s: torch.randn(*s, dtype=torch.bfloat16) * 0.8)(F, S) * (F ** -0.5)),
            "b2": _w((lambda *s: torch.randn(*s, dtype=torch.bfloat16) * 0.8)(S) * 0.02),
        }
    _B_in = _B_setup()

    return {
        "A_x": _A_in["x"],
        "A_wqkv": _A_in["wqkv"],
        "A_wo": _A_in["wo"],
        "B_x": _B_in["x"],
        "B_w1": _B_in["w1"],
        "B_b1": _B_in["b1"],
        "B_w2": _B_in["w2"],
        "B_b2": _B_in["b2"],
        "gate_w": _w((lambda *s: torch.randn(*s, dtype=torch.bfloat16) * 0.05)(640) * 16.0),
    }

def reference(A_x, A_wqkv, A_wo, B_x, B_w1, B_b1, B_w2, B_b2, gate_w):
    def _A_ref(x, wqkv, wo):
        B, S, D = x.shape
        H = 32; Dh = D // H
        W, dil = 8, 2
        qkv = (lambda x, *d: x.permute(*d))((x @ wqkv).reshape(B, S, 3, H, Dh), 2, 0, 3, 1, 4)
        q, k, v = qkv[0], qkv[1], qkv[2]
        scale = Dh ** -0.5
        pos = torch.arange(S)
        off = torch.arange(W) * dil
        idx = pos[:, None] - off[None, :]
        mask = idx >= 0
        idx_c = torch.where(mask, idx, 0).reshape(-1)
        kg = k[:, :, idx_c, :].reshape(B, H, S, W, Dh)
        vg = v[:, :, idx_c, :].reshape(B, H, S, W, Dh)
        logits = torch.einsum("bhsd,bhswd->bhsw", q, kg) * scale
        logits = torch.where(mask[None, None, :, :], logits, -1e9)
        attn = _softmax(logits, axis=-1)
        o = torch.einsum("bhsw,bhswd->bhsd", attn, vg)
        return (lambda x, *d: x.permute(*d))(o, 0, 2, 1, 3).reshape(B, S, D) @ wo

    def _B_ref(x, w1, b1, w2, b2):
        B, S, D = x.shape
        h = _layernorm(x, axis=-1)
        u = torch.einsum("bsd,sf->bdf", h, w1) + b1
        u = _gelu(u)
        y = torch.einsum("bdf,fs->bds", u, w2) + b2
        return (lambda x, *d: x.permute(*d))(y, 0, 2, 1)

    x = A_x
    g = _sigmoid((x * gate_w).sum(-1, keepdims=True))
    a = _A_ref(x, A_wqkv, A_wo)
    b = _B_ref(x, B_w1, B_b1, B_w2, B_b2)
    return g * a + (1 - g) * b
```

```asm
; @launch grid=(256,1,1) block=(512,1,1) lds=163840
.amdgcn_target "amdgcn-amd-amdhsa--gfx950"
.text
.globl gated_mix__sliding_local_dilated__mixer_token_mlp__prompt_kernel
.p2align 8
.type gated_mix__sliding_local_dilated__mixer_token_mlp__prompt_kernel,@function
gated_mix__sliding_local_dilated__mixer_token_mlp__prompt_kernel:
    s_cmp_ge_u32 s2, 256
    s_cbranch_scc1 Lend
    s_load_dwordx2 s[20:21], s[0:1], 88
    v_lshrrev_b32 v1, 6, v0
    s_nop 0
    v_readfirstlane_b32 s3, v1
    v_and_b32 v1, 63, v0
    s_and_b32 s52, s2, 7
    s_lshr_b32 s53, s2, 3
    s_lshr_b32 s22, s52, 1
    s_lshl_b32 s50, s22, 3
    s_and_b32 s23, s53, 7
    s_add_u32 s50, s50, s23
    s_lshr_b32 s26, s53, 3
    s_bitcmp1_b32 s52, 0
    s_cbranch_scc1 Lrole_qa
    s_and_b32 s54, s23, 0
    s_cselect_b32 s51, 5, 4
    s_mul_i32 s51, s51, s26
    s_lshl_b32 s19, s22, 5
    s_add_u32 s19, s19, s53
    s_mul_i32 s17, s53, 86
    s_lshr_b32 s17, s17, 8
    s_mul_i32 s23, s17, 3
    s_sub_u32 s23, s53, s23
    s_mul_i32 s16, s22, 3
    s_add_u32 s16, s16, s23
    s_mul_i32 s18, s17, 205
    s_lshr_b32 s18, s18, 6
    s_cmp_ge_u32 s3, 4
    s_cbranch_scc1 Lg_cons
    s_setprio 1
    s_cmp_ge_u32 s3, 2
    s_cbranch_scc1 Lg_h
    s_load_dwordx2 s[4:5], s[0:1], 32
    s_waitcnt lgkmcnt(0)
    s_add_u32 s44, s20, 8454144
    s_addc_u32 s45, s21, 0
    s_mov_b32 s46, 458752
    s_mov_b32 s47, 0x20000
    s_load_dword s48, s[44:45], 262144
    s_cmp_ge_u32 s53, 30
    s_cbranch_scc1 Lsp_w
    v_lshrrev_b32 v2, 4, v1
    s_lshl_b32 s23, s3, 2
    v_add_u32 v2, s23, v2
    v_lshlrev_b32 v4, 1, v2
    v_and_b32 v3, 15, v1
    v_xor_b32 v3, v3, v4
    v_lshlrev_b32 v3, 4, v3
    v_mul_u32_u24 v2, 3072, v2
    s_lshl_b32 s26, s16, 8
    v_add3_u32 v8, v2, v3, s26
    v_add_u32 v9, 24576, v8
    v_add_u32 v10, 49152, v8
    v_add_u32 v11, 73728, v8
    v_add_u32 v12, 98304, v8
    v_add_u32 v13, 122880, v8
    v_add_u32 v14, 147456, v8
    v_add_u32 v15, 172032, v8
    s_mov_b32 s34, s18
    s_lshl_b32 s37, s3, 10
    s_add_u32 s38, s37, 147456
    s_mov_b32 s33, 0
    s_mov_b32 s6, 6291456
    s_mov_b32 s7, 0x20000
    s_barrier
    s_add_u32 s32, s33, 1
Li1:
    s_mul_i32 s40, s34, 196608
    s_add_u32 m0, s37, 0
    s_nop 0
    buffer_load_dwordx4 v8, s[4:7], s40 offen lds
    s_add_u32 m0, s37, 2048
    s_nop 0
    buffer_load_dwordx4 v9, s[4:7], s40 offen lds
    s_add_u32 m0, s37, 4096
    s_nop 0
    buffer_load_dwordx4 v10, s[4:7], s40 offen lds
    s_add_u32 m0, s37, 6144
    s_nop 0
    buffer_load_dwordx4 v11, s[4:7], s40 offen lds
    s_add_u32 m0, s37, 8192
    s_nop 0
    buffer_load_dwordx4 v12, s[4:7], s40 offen lds
    s_add_u32 m0, s37, 10240
    s_nop 0
    buffer_load_dwordx4 v13, s[4:7], s40 offen lds
    s_add_u32 m0, s37, 12288
    s_nop 0
    buffer_load_dwordx4 v14, s[4:7], s40 offen lds
    s_add_u32 m0, s37, 14336
    s_nop 0
    buffer_load_dwordx4 v15, s[4:7], s40 offen lds
    s_add_u32 s37, s37, 24576
    s_cmp_ge_u32 s37, s38
    s_cselect_b32 s42, 147456, 0
    s_sub_u32 s37, s37, s42
    s_add_u32 s34, s34, 1
    s_and_b32 s34, s34, 31
    s_add_u32 s33, s33, 1
    s_cmp_lt_u32 s33, s32
    s_cbranch_scc1 Li1
    s_waitcnt lgkmcnt(0)
    s_mul_i32 s48, s48, 1664525
    s_add_u32 s48, s48, 1013904223
    s_barrier
    s_add_u32 s32, s33, 5
Li2:
    s_mul_i32 s40, s34, 196608
    s_add_u32 m0, s37, 0
    s_nop 0
    buffer_load_dwordx4 v8, s[4:7], s40 offen lds
    s_add_u32 m0, s37, 2048
    s_nop 0
    buffer_load_dwordx4 v9, s[4:7], s40 offen lds
    s_add_u32 m0, s37, 4096
    s_nop 0
    buffer_load_dwordx4 v10, s[4:7], s40 offen lds
    s_add_u32 m0, s37, 6144
    s_nop 0
    buffer_load_dwordx4 v11, s[4:7], s40 offen lds
    s_add_u32 m0, s37, 8192
    s_nop 0
    buffer_load_dwordx4 v12, s[4:7], s40 offen lds
    s_add_u32 m0, s37, 10240
    s_nop 0
    buffer_load_dwordx4 v13, s[4:7], s40 offen lds
    s_add_u32 m0, s37, 12288
    s_nop 0
    buffer_load_dwordx4 v14, s[4:7], s40 offen lds
    s_add_u32 m0, s37, 14336
    s_nop 0
    buffer_load_dwordx4 v15, s[4:7], s40 offen lds
    s_add_u32 s37, s37, 24576
    s_cmp_ge_u32 s37, s38
    s_cselect_b32 s42, 147456, 0
    s_sub_u32 s37, s37, s42
    s_add_u32 s34, s34, 1
    s_and_b32 s34, s34, 31
    s_add_u32 s33, s33, 1
    s_cmp_lt_u32 s33, s32
    s_cbranch_scc1 Li2
    s_waitcnt vmcnt(40)
    s_barrier
    s_waitcnt vmcnt(32)
    s_barrier
Ls3:
    s_waitcnt vmcnt(24)
    s_barrier
    s_mul_i32 s40, s34, 196608
    s_add_u32 m0, s37, 0
    s_nop 0
    buffer_load_dwordx4 v8, s[4:7], s40 offen lds
    s_add_u32 m0, s37, 2048
    s_nop 0
    buffer_load_dwordx4 v9, s[4:7], s40 offen lds
    s_add_u32 m0, s37, 4096
    s_nop 0
    buffer_load_dwordx4 v10, s[4:7], s40 offen lds
    s_add_u32 m0, s37, 6144
    s_nop 0
    buffer_load_dwordx4 v11, s[4:7], s40 offen lds
    s_add_u32 m0, s37, 8192
    s_nop 0
    buffer_load_dwordx4 v12, s[4:7], s40 offen lds
    s_add_u32 m0, s37, 10240
    s_nop 0
    buffer_load_dwordx4 v13, s[4:7], s40 offen lds
    s_add_u32 m0, s37, 12288
    s_nop 0
    buffer_load_dwordx4 v14, s[4:7], s40 offen lds
    s_add_u32 m0, s37, 14336
    s_nop 0
    buffer_load_dwordx4 v15, s[4:7], s40 offen lds
    s_add_u32 s37, s37, 24576
    s_cmp_ge_u32 s37, s38
    s_cselect_b32 s42, 147456, 0
    s_sub_u32 s37, s37, s42
    s_add_u32 s34, s34, 1
    s_and_b32 s34, s34, 31
    s_add_u32 s33, s33, 1
    s_cmp_lt_u32 s33, 32
    s_cbranch_scc1 Ls3
    s_waitcnt vmcnt(24)
    s_barrier
    s_waitcnt vmcnt(16)
    s_barrier
    s_waitcnt vmcnt(8)
    s_barrier
    s_waitcnt vmcnt(0)
    s_barrier
    s_branch Lp2_s0
Lsp_w:
    s_barrier
    s_waitcnt lgkmcnt(0)
    s_mul_i32 s48, s48, 1664525
    s_add_u32 s48, s48, 1013904223
    s_barrier
Lsp_l:
    s_lshr_b32 s16, s52, 1
    s_lshl_b32 s16, s16, 1
    s_add_u32 s16, s16, s53
    s_sub_u32 s16, s16, 30
    s_lshl_b32 s23, s52, 14
    v_lshl_add_u32 v12, v1, 7, s23
    s_mov_b32 s49, 0
    s_mov_b32 exec_lo, 1
    s_mov_b32 exec_hi, 0
Lg4:
    buffer_load_dword v2, v12, s[44:47], 0 offen sc1
    s_waitcnt vmcnt(0)
    v_xor_b32 v2, s48, v2
    v_cmp_ne_u32 vcc, 0, v2
    s_add_u32 s49, s49, 1
    s_cmp_eq_u64 vcc, 0
    s_cbranch_scc1 Lg4d
    s_sleep 16
    s_cmp_lt_u32 s49, 20000
    s_cbranch_scc1 Lg4
Lg4d:
    s_mov_b64 exec, -1
    s_load_dwordx2 s[4:5], s[0:1], 16
    s_load_dwordx2 s[12:13], s[0:1], 48
    v_lshrrev_b32 v2, 3, v1
    v_and_b32 v3, 7, v1
    v_and_b32 v4, 6, v2
    v_xor_b32 v3, v3, v4
    v_lshlrev_b32 v14, 4, v3
    v_mul_u32_u24 v15, 1280, v2
    v_add_u32 v15, v15, v14
    v_lshrrev_b32 v3, 2, v2
    v_lshl_add_u32 v3, v3, 4, v2
    v_add_u32 v3, 16, v3
    v_mul_u32_u24 v3, 1280, v3
    v_add_u32 v14, v14, v3
    s_mul_i32 s23, s3, 28672
    v_lshrrev_b32 v5, 2, v1
    v_lshrrev_b32 v6, 1, v5
    v_and_b32 v6, 3, v6
    v_lshlrev_b32 v5, 7, v5
    v_and_b32 v7, 3, v1
    v_lshlrev_b32 v7, 3, v7
    v_add3_u32 v5, v5, v7, s23
    v_xor_b32 v7, 0, v6
    v_lshl_add_u32 v8, v7, 5, v5
    v_xor_b32 v7, 1, v6
    v_lshl_add_u32 v9, v7, 5, v5
    v_xor_b32 v7, 2, v6
    v_lshl_add_u32 v10, v7, 5, v5
    v_xor_b32 v7, 3, v6
    v_lshl_add_u32 v11, v7, 5, v5
    v_lshlrev_b32 v12, 4, v1
    s_lshl_b32 s26, s16, 7
    s_add_u32 s26, s26, 327680
    v_lshl_add_u32 v13, v1, 10, s26
    s_waitcnt lgkmcnt(0)
    s_mov_b32 s6, 819200
    s_mov_b32 s7, 0x20000
    s_add_u32 s8, s20, 5242880
    s_addc_u32 s9, s21, 0
    s_mov_b32 s10, 2785280
    s_mov_b32 s11, 0x20000
    s_mov_b32 s14, 6291456
    s_mov_b32 s15, 0x20000
    s_mov_b32 s33, 0
Lwo5:
    s_lshl_b32 s26, s33, 2
    s_add_u32 s26, s26, s3
    s_min_u32 s26, s26, 24
    s_mul_i32 s27, s16, 25
    s_add_u32 s27, s27, s26
    s_mul_i32 s26, s27, 6554
    s_lshr_b32 s26, s26, 16
    s_mul_i32 s28, s26, 10
    s_sub_u32 s27, s27, s28
    s_lshl_b32 s28, s26, 1
    s_add_u32 s28, s28, 0
    s_mul_i32 s29, s28, 52
    s_lshr_b32 s29, s29, 8
    s_mul_i32 s30, s29, 5
    s_sub_u32 s28, s28, s30
    s_mul_i32 s29, s29, 80
    s_mul_i32 s30, s28, 20
    s_cmp_eq_u32 s28, 4
    s_cselect_b64 vcc, -1, 0
    s_cselect_b32 s30, 0, s30
    s_cselect_b32 s31, 40, 8
    s_mul_i32 s31, s31, 1280
    s_add_u32 s29, s29, s30
    s_mul_i32 s28, s29, 1280
    s_lshl_b32 s29, s27, 7
    s_add_u32 s28, s28, s29
    v_cndmask_b32 v2, v15, v14, vcc
    s_add_u32 m0, s23, 0
    s_nop 0
    buffer_load_dwordx4 v2, s[4:7], s28 offen lds
    s_add_u32 s28, s28, s31
    s_add_u32 m0, s23, 1024
    s_nop 0
    buffer_load_dwordx4 v2, s[4:7], s28 offen lds
    s_add_u32 s28, s28, s31
    s_lshl_b32 s28, s26, 1
    s_add_u32 s28, s28, 1
    s_mul_i32 s29, s28, 52
    s_lshr_b32 s29, s29, 8
    s_mul_i32 s30, s29, 5
    s_sub_u32 s28, s28, s30
    s_mul_i32 s29, s29, 80
    s_mul_i32 s30, s28, 20
    s_cmp_eq_u32 s28, 4
    s_cselect_b64 vcc, -1, 0
    s_cselect_b32 s30, 0, s30
    s_cselect_b32 s31, 40, 8
    s_mul_i32 s31, s31, 1280
    s_add_u32 s29, s29, s30
    s_mul_i32 s28, s29, 1280
    s_lshl_b32 s29, s27, 7
    s_add_u32 s28, s28, s29
    v_cndmask_b32 v2, v15, v14, vcc
    s_add_u32 m0, s23, 2048
    s_nop 0
    buffer_load_dwordx4 v2, s[4:7], s28 offen lds
    s_add_u32 s28, s28, s31
    s_add_u32 m0, s23, 3072
    s_nop 0
    buffer_load_dwordx4 v2, s[4:7], s28 offen lds
    s_add_u32 s28, s28, s31
    s_add_u32 s23, s23, 4096
    s_add_u32 s33, s33, 1
    s_cmp_lt_u32 s33, 7
    s_cbranch_scc1 Lwo5
    s_waitcnt vmcnt(0)
    s_mov_b32 s33, 0
Lwo6:
    s_lshl_b32 s26, s33, 2
    s_add_u32 s26, s26, s3
    s_min_u32 s26, s26, 24
    s_mul_i32 s27, s16, 25
    s_add_u32 s27, s27, s26
    s_mul_i32 s26, s27, 6554
    s_lshr_b32 s26, s26, 16
    s_mul_i32 s28, s26, 10
    s_sub_u32 s27, s27, s28
    ds_read_b64_tr_b16 v[16:17], v8
    ds_read_b64_tr_b16 v[18:19], v8 offset:2048
    v_add_u32 v8, 4096, v8
    ds_read_b64_tr_b16 v[20:21], v9
    ds_read_b64_tr_b16 v[22:23], v9 offset:2048
    v_add_u32 v9, 4096, v9
    ds_read_b64_tr_b16 v[24:25], v10
    ds_read_b64_tr_b16 v[26:27], v10 offset:2048
    v_add_u32 v10, 4096, v10
    ds_read_b64_tr_b16 v[28:29], v11
    ds_read_b64_tr_b16 v[30:31], v11 offset:2048
    v_add_u32 v11, 4096, v11
    s_lshl_b32 s28, s27, 2
    s_mul_i32 s28, s28, 68
    s_add_u32 s28, s28, s26
    s_add_u32 s28, s28, 48
    s_lshl_b32 s28, s28, 10
    s_waitcnt lgkmcnt(6)
    buffer_store_dwordx4 v[16:19], v12, s[8:11], s28 offen sc1
    s_add_u32 s28, s28, 69632
    s_waitcnt lgkmcnt(4)
    buffer_store_dwordx4 v[20:23], v12, s[8:11], s28 offen sc1
    s_add_u32 s28, s28, 69632
    s_waitcnt lgkmcnt(2)
    buffer_store_dwordx4 v[24:27], v12, s[8:11], s28 offen sc1
    s_add_u32 s28, s28, 69632
    s_waitcnt lgkmcnt(0)
    buffer_store_dwordx4 v[28:31], v12, s[8:11], s28 offen sc1
    s_add_u32 s28, s28, 69632
    s_add_u32 s33, s33, 1
    s_cmp_lt_u32 s33, 7
    s_cbranch_scc1 Lwo6
    s_waitcnt vmcnt(0)
    s_mov_b64 exec, 1
    v_mov_b32 v2, 163784
    v_mov_b32 v3, 1
    ds_add_rtn_u32 v3, v2, v3
    s_waitcnt lgkmcnt(0)
    v_readfirstlane_b32 s22, v3
    s_mov_b64 exec, 255
    s_cmp_lg_u32 s22, 3
    s_cbranch_scc1 Lpub7
    v_mov_b32 v3, s48
    buffer_store_dword v3, v13, s[44:47], 0 offen sc1
Lpub7:
    s_mov_b64 exec, -1
    s_cmp_ge_u32 s3, 2
    s_cbranch_scc1 Lp2_d0
    s_branch Lp2_s0
Lg_h:
    s_waitcnt lgkmcnt(0)
    s_add_u32 s44, s20, 8454144
    s_addc_u32 s45, s21, 0
    s_mov_b32 s46, 458752
    s_mov_b32 s47, 0x20000
    s_load_dword s48, s[44:45], 262144
    s_barrier
    s_cmp_lt_u32 s53, 30
    s_cbranch_scc1 Lg_h2
    s_waitcnt lgkmcnt(0)
    s_mul_i32 s48, s48, 1664525
    s_add_u32 s48, s48, 1013904223
    s_barrier
    s_branch Lsp_l
Lg_h2:
    v_lshrrev_b32 v2, 3, v1
    v_and_b32 v3, 7, v1
    v_and_b32 v4, 6, v2
    v_xor_b32 v3, v3, v4
    v_lshlrev_b32 v3, 4, v3
    s_sub_u32 s22, s3, 2
    s_lshl_b32 s23, s22, 3
    v_add_u32 v2, s23, v2
    v_mul_u32_u24 v2, 1280, v2
    s_lshl_b32 s26, s17, 7
    v_add3_u32 v8, v2, v3, s26
    v_add_u32 v9, 20480, v8
    v_add_u32 v10, 40960, v8
    v_add_u32 v11, 61440, v8
    s_lshl_b32 s23, s52, 14
    v_lshl_add_u32 v12, v1, 7, s23
    s_mov_b32 s34, s18
    s_lshl_b32 s37, s22, 10
    s_add_u32 s37, s37, 16384
    s_add_u32 s38, s37, 147456
    s_mov_b32 s33, 0
    s_mov_b32 s4, s20
    s_mov_b32 s5, s21
    s_mov_b32 s6, 2621440
    s_mov_b32 s7, 0x20000
    s_waitcnt lgkmcnt(0)
    s_mul_i32 s48, s48, 1664525
    s_add_u32 s48, s48, 1013904223
    s_barrier
    s_sub_u32 s22, s3, 2
    s_lshl_b32 s22, s22, 13
    v_add_u32 v12, s22, v12
    s_mov_b32 s49, 0
    s_mov_b32 exec_lo, 4294967295
    s_mov_b32 exec_hi, 4294967295
Lg9:
    buffer_load_dword v2, v12, s[44:47], 0 offen sc1
    s_waitcnt vmcnt(0)
    v_xor_b32 v2, s48, v2
    v_cmp_ne_u32 vcc, 0, v2
    s_add_u32 s49, s49, 1
    s_cmp_eq_u64 vcc, 0
    s_cbranch_scc1 Lg9d
    s_sleep 8
    s_cmp_lt_u32 s49, 20000
    s_cbranch_scc1 Lg9
Lg9d:
    s_mov_b64 exec, -1
    v_mov_b32 v2, 163788
    v_mov_b32 v3, 1
    s_mov_b64 exec, 1
    ds_add_u32 v2, v3
    s_mov_b32 s49, 0
Lm8:
    ds_read_b32 v3, v2
    s_add_u32 s49, s49, 1
    s_waitcnt lgkmcnt(0)
    v_readfirstlane_b32 s22, v3
    s_nop 0
    s_cmp_ge_u32 s22, 2
    s_cbranch_scc1 Lm8d
    s_cmp_lt_u32 s49, 0x400000
    s_cbranch_scc1 Lm8
Lm8d:
    s_mov_b64 exec, -1
    s_add_u32 s32, s33, 4
Li10:
    s_mul_i32 s40, s34, 81920
    s_add_u32 m0, s37, 0
    s_nop 0
    buffer_load_dwordx4 v8, s[4:7], s40 offen sc1 lds
    s_add_u32 m0, s37, 2048
    s_nop 0
    buffer_load_dwordx4 v9, s[4:7], s40 offen sc1 lds
    s_add_u32 m0, s37, 4096
    s_nop 0
    buffer_load_dwordx4 v10, s[4:7], s40 offen sc1 lds
    s_add_u32 m0, s37, 6144
    s_nop 0
    buffer_load_dwordx4 v11, s[4:7], s40 offen sc1 lds
    s_add_u32 s37, s37, 24576
    s_cmp_ge_u32 s37, s38
    s_cselect_b32 s42, 147456, 0
    s_sub_u32 s37, s37, s42
    s_add_u32 s34, s34, 1
    s_and_b32 s34, s34, 31
    s_add_u32 s33, s33, 1
    s_cmp_lt_u32 s33, s32
    s_cbranch_scc1 Li10
Ls11:
    s_waitcnt vmcnt(12)
    s_barrier
    s_mul_i32 s40, s34, 81920
    s_add_u32 m0, s37, 0
    s_nop 0
    buffer_load_dwordx4 v8, s[4:7], s40 offen sc1 lds
    s_add_u32 m0, s37, 2048
    s_nop 0
    buffer_load_dwordx4 v9, s[4:7], s40 offen sc1 lds
    s_add_u32 m0, s37, 4096
    s_nop 0
    buffer_load_dwordx4 v10, s[4:7], s40 offen sc1 lds
    s_add_u32 m0, s37, 6144
    s_nop 0
    buffer_load_dwordx4 v11, s[4:7], s40 offen sc1 lds
    s_add_u32 s37, s37, 24576
    s_cmp_ge_u32 s37, s38
    s_cselect_b32 s42, 147456, 0
    s_sub_u32 s37, s37, s42
    s_add_u32 s34, s34, 1
    s_and_b32 s34, s34, 31
    s_add_u32 s33, s33, 1
    s_cmp_lt_u32 s33, 32
    s_cbranch_scc1 Ls11
    s_waitcnt vmcnt(12)
    s_barrier
    s_waitcnt vmcnt(8)
    s_barrier
    s_waitcnt vmcnt(4)
    s_barrier
    s_waitcnt vmcnt(0)
    s_barrier
    s_branch Lp2_d0
Lg_cons:
    s_setprio 2
    s_load_dwordx2 s[4:5], s[0:1], 0
    s_load_dwordx2 s[8:9], s[0:1], 64
    s_sub_u32 s3, s3, 4
    s_lshl_b32 s22, s19, 4
    s_lshl_b32 s23, s3, 2
    s_add_u32 s22, s22, s23
    v_lshrrev_b32 v2, 4, v1
    v_add_u32 v10, s22, v2
    v_and_b32 v11, 15, v1
    v_lshlrev_b32 v4, 4, v11
    v_mul_u32_u24 v5, 1280, v10
    v_add_u32 v5, v5, v4
    s_waitcnt lgkmcnt(0)
    s_mov_b32 s6, 2621440
    s_mov_b32 s7, 0x20000
    s_mov_b32 s10, 1280
    s_mov_b32 s11, 0x20000
    buffer_load_dwordx4 v[16:19], v5, s[4:7], 0 offen offset:0
    buffer_load_dwordx4 v[20:23], v5, s[4:7], 0 offen offset:256
    buffer_load_dwordx4 v[24:27], v5, s[4:7], 0 offen offset:512
    buffer_load_dwordx4 v[28:31], v5, s[4:7], 0 offen offset:768
    buffer_load_dwordx4 v[32:35], v5, s[4:7], 0 offen offset:1024
    buffer_load_dwordx4 v[36:39], v4, s[8:11], 0 offen offset:0
    buffer_load_dwordx4 v[40:43], v4, s[8:11], 0 offen offset:256
    buffer_load_dwordx4 v[44:47], v4, s[8:11], 0 offen offset:512
    buffer_load_dwordx4 v[48:51], v4, s[8:11], 0 offen offset:768
    buffer_load_dwordx4 v[52:55], v4, s[8:11], 0 offen offset:1024
    s_add_u32 s44, s20, 8454144
    s_addc_u32 s45, s21, 0
    s_mov_b32 s46, 458752
    s_mov_b32 s47, 0x20000
    v_mov_b32 v2, 163776
    v_mov_b32 v6, 0
    v_mov_b32 v7, 0
    v_mov_b32 v8, 0
    v_mov_b32 v9, 0
    ds_write_b128 v2, v[6:9]
    s_waitcnt lgkmcnt(0)
    s_barrier
    s_load_dword s48, s[44:45], 262144
    s_mov_b32 s4, s20
    s_mov_b32 s5, s21
    s_mov_b32 s6, 2621440
    s_mov_b32 s7, 0x20000
    s_add_u32 s8, s20, 8388608
    s_addc_u32 s9, s21, 0
    s_mov_b32 s10, 16384
    s_mov_b32 s11, 0x20000
    s_mov_b32 s30, 0x3f803f80
    s_mov_b32 s31, 0xffff0000
    s_waitcnt vmcnt(5)
    v_dot2_f32_bf16 v6, v16, s30, 0
    v_dot2_f32_bf16 v8, v17, s30, 0
    v_dot2_f32_bf16 v6, v18, s30, v6
    v_dot2_f32_bf16 v8, v19, s30, v8
    v_dot2_f32_bf16 v6, v20, s30, v6
    v_dot2_f32_bf16 v8, v21, s30, v8
    v_dot2_f32_bf16 v6, v22, s30, v6
    v_dot2_f32_bf16 v8, v23, s30, v8
    v_dot2_f32_bf16 v6, v24, s30, v6
    v_dot2_f32_bf16 v8, v25, s30, v8
    v_dot2_f32_bf16 v6, v26, s30, v6
    v_dot2_f32_bf16 v8, v27, s30, v8
    v_dot2_f32_bf16 v6, v28, s30, v6
    v_dot2_f32_bf16 v8, v29, s30, v8
    v_dot2_f32_bf16 v6, v30, s30, v6
    v_dot2_f32_bf16 v8, v31, s30, v8
    v_dot2_f32_bf16 v6, v32, s30, v6
    v_dot2_f32_bf16 v8, v33, s30, v8
    v_dot2_f32_bf16 v6, v34, s30, v6
    v_dot2_f32_bf16 v8, v35, s30, v8
    v_lshlrev_b32 v56, 16, v16
    v_and_b32 v57, s31, v16
    v_lshlrev_b32 v58, 16, v17
    v_and_b32 v59, s31, v17
    v_lshlrev_b32 v60, 16, v18
    v_and_b32 v61, s31, v18
    v_lshlrev_b32 v62, 16, v19
    v_and_b32 v63, s31, v19
    v_lshlrev_b32 v64, 16, v20
    v_and_b32 v65, s31, v20
    v_lshlrev_b32 v66, 16, v21
    v_and_b32 v67, s31, v21
    v_lshlrev_b32 v68, 16, v22
    v_and_b32 v69, s31, v22
    v_lshlrev_b32 v70, 16, v23
    v_and_b32 v71, s31, v23
    v_lshlrev_b32 v72, 16, v24
    v_and_b32 v73, s31, v24
    v_lshlrev_b32 v74, 16, v25
    v_and_b32 v75, s31, v25
    v_lshlrev_b32 v76, 16, v26
    v_and_b32 v77, s31, v26
    v_lshlrev_b32 v78, 16, v27
    v_and_b32 v79, s31, v27
    v_lshlrev_b32 v80, 16, v28
    v_and_b32 v81, s31, v28
    v_lshlrev_b32 v82, 16, v29
    v_and_b32 v83, s31, v29
    v_lshlrev_b32 v84, 16, v30
    v_and_b32 v85, s31, v30
    v_lshlrev_b32 v86, 16, v31
    v_and_b32 v87, s31, v31
    v_lshlrev_b32 v88, 16, v32
    v_and_b32 v89, s31, v32
    v_lshlrev_b32 v90, 16, v33
    v_and_b32 v91, s31, v33
    v_lshlrev_b32 v92, 16, v34
    v_and_b32 v93, s31, v34
    v_lshlrev_b32 v94, 16, v35
    v_and_b32 v95, s31, v35
    v_add_f32 v6, v6, v8
    s_nop 1
    v_add_f32_dpp v6, v6, v6 row_ror:8 row_mask:0xf bank_mask:0xf
    s_nop 1
    v_add_f32_dpp v6, v6, v6 row_ror:4 row_mask:0xf bank_mask:0xf
    s_nop 1
    v_add_f32_dpp v6, v6, v6 row_ror:2 row_mask:0xf bank_mask:0xf
    s_nop 1
    v_add_f32_dpp v6, v6, v6 row_ror:1 row_mask:0xf bank_mask:0xf
    v_mul_f32 v6, 0x3acccccd, v6
    v_pk_add_f32 v[56:57], v[56:57], v[6:7] op_sel_hi:[1,0] neg_lo:[0,1] neg_hi:[0,1]
    v_pk_add_f32 v[58:59], v[58:59], v[6:7] op_sel_hi:[1,0] neg_lo:[0,1] neg_hi:[0,1]
    v_pk_add_f32 v[60:61], v[60:61], v[6:7] op_sel_hi:[1,0] neg_lo:[0,1] neg_hi:[0,1]
    v_pk_add_f32 v[62:63], v[62:63], v[6:7] op_sel_hi:[1,0] neg_lo:[0,1] neg_hi:[0,1]
    v_pk_add_f32 v[64:65], v[64:65], v[6:7] op_sel_hi:[1,0] neg_lo:[0,1] neg_hi:[0,1]
    v_pk_add_f32 v[66:67], v[66:67], v[6:7] op_sel_hi:[1,0] neg_lo:[0,1] neg_hi:[0,1]
    v_pk_add_f32 v[68:69], v[68:69], v[6:7] op_sel_hi:[1,0] neg_lo:[0,1] neg_hi:[0,1]
    v_pk_add_f32 v[70:71], v[70:71], v[6:7] op_sel_hi:[1,0] neg_lo:[0,1] neg_hi:[0,1]
    v_pk_add_f32 v[72:73], v[72:73], v[6:7] op_sel_hi:[1,0] neg_lo:[0,1] neg_hi:[0,1]
    v_pk_add_f32 v[74:75], v[74:75], v[6:7] op_sel_hi:[1,0] neg_lo:[0,1] neg_hi:[0,1]
    v_pk_add_f32 v[76:77], v[76:77], v[6:7] op_sel_hi:[1,0] neg_lo:[0,1] neg_hi:[0,1]
    v_pk_add_f32 v[78:79], v[78:79], v[6:7] op_sel_hi:[1,0] neg_lo:[0,1] neg_hi:[0,1]
    v_pk_add_f32 v[80:81], v[80:81], v[6:7] op_sel_hi:[1,0] neg_lo:[0,1] neg_hi:[0,1]
    v_pk_add_f32 v[82:83], v[82:83], v[6:7] op_sel_hi:[1,0] neg_lo:[0,1] neg_hi:[0,1]
    v_pk_add_f32 v[84:85], v[84:85], v[6:7] op_sel_hi:[1,0] neg_lo:[0,1] neg_hi:[0,1]
    v_pk_add_f32 v[86:87], v[86:87], v[6:7] op_sel_hi:[1,0] neg_lo:[0,1] neg_hi:[0,1]
    v_pk_add_f32 v[88:89], v[88:89], v[6:7] op_sel_hi:[1,0] neg_lo:[0,1] neg_hi:[0,1]
    v_pk_add_f32 v[90:91], v[90:91], v[6:7] op_sel_hi:[1,0] neg_lo:[0,1] neg_hi:[0,1]
    v_pk_add_f32 v[92:93], v[92:93], v[6:7] op_sel_hi:[1,0] neg_lo:[0,1] neg_hi:[0,1]
    v_pk_add_f32 v[94:95], v[94:95], v[6:7] op_sel_hi:[1,0] neg_lo:[0,1] neg_hi:[0,1]
    v_pk_mul_f32 v[12:13], v[56:57], v[56:57]
    v_pk_mul_f32 v[14:15], v[58:59], v[58:59]
    v_pk_fma_f32 v[12:13], v[60:61], v[60:61], v[12:13]
    v_pk_fma_f32 v[14:15], v[62:63], v[62:63], v[14:15]
    v_pk_fma_f32 v[12:13], v[64:65], v[64:65], v[12:13]
    v_pk_fma_f32 v[14:15], v[66:67], v[66:67], v[14:15]
    v_pk_fma_f32 v[12:13], v[68:69], v[68:69], v[12:13]
    v_pk_fma_f32 v[14:15], v[70:71], v[70:71], v[14:15]
    v_pk_fma_f32 v[12:13], v[72:73], v[72:73], v[12:13]
    v_pk_fma_f32 v[14:15], v[74:75], v[74:75], v[14:15]
    v_pk_fma_f32 v[12:13], v[76:77], v[76:77], v[12:13]
    v_pk_fma_f32 v[14:15], v[78:79], v[78:79], v[14:15]
    v_pk_fma_f32 v[12:13], v[80:81], v[80:81], v[12:13]
    v_pk_fma_f32 v[14:15], v[82:83], v[82:83], v[14:15]
    v_pk_fma_f32 v[12:13], v[84:85], v[84:85], v[12:13]
    v_pk_fma_f32 v[14:15], v[86:87], v[86:87], v[14:15]
    v_pk_fma_f32 v[12:13], v[88:89], v[88:89], v[12:13]
    v_pk_fma_f32 v[14:15], v[90:91], v[90:91], v[14:15]
    v_pk_fma_f32 v[12:13], v[92:93], v[92:93], v[12:13]
    v_pk_fma_f32 v[14:15], v[94:95], v[94:95], v[14:15]
    v_pk_add_f32 v[12:13], v[12:13], v[14:15]
    v_add_f32 v12, v12, v13
    s_nop 1
    v_add_f32_dpp v12, v12, v12 row_ror:8 row_mask:0xf bank_mask:0xf
    s_nop 1
    v_add_f32_dpp v12, v12, v12 row_ror:4 row_mask:0xf bank_mask:0xf
    s_nop 1
    v_add_f32_dpp v12, v12, v12 row_ror:2 row_mask:0xf bank_mask:0xf
    s_nop 1
    v_add_f32_dpp v12, v12, v12 row_ror:1 row_mask:0xf bank_mask:0xf
    v_mov_b32 v8, 0x3727c5ac
    v_fmac_f32 v8, 0x3acccccd, v12
    v_rsq_f32 v12, v8
    s_nop 0
    v_pk_mul_f32 v[56:57], v[56:57], v[12:13] op_sel_hi:[1,0]
    v_pk_mul_f32 v[58:59], v[58:59], v[12:13] op_sel_hi:[1,0]
    v_pk_mul_f32 v[60:61], v[60:61], v[12:13] op_sel_hi:[1,0]
    v_pk_mul_f32 v[62:63], v[62:63], v[12:13] op_sel_hi:[1,0]
    v_cvt_pk_bf16_f32 v96, v56, v57
    v_cvt_pk_bf16_f32 v97, v58, v59
    v_cvt_pk_bf16_f32 v98, v60, v61
    v_cvt_pk_bf16_f32 v99, v62, v63
    buffer_store_dwordx4 v[96:99], v5, s[4:7], 0 offen offset:0 sc1
    v_pk_mul_f32 v[64:65], v[64:65], v[12:13] op_sel_hi:[1,0]
    v_pk_mul_f32 v[66:67], v[66:67], v[12:13] op_sel_hi:[1,0]
    v_pk_mul_f32 v[68:69], v[68:69], v[12:13] op_sel_hi:[1,0]
    v_pk_mul_f32 v[70:71], v[70:71], v[12:13] op_sel_hi:[1,0]
    v_cvt_pk_bf16_f32 v100, v64, v65
    v_cvt_pk_bf16_f32 v101, v66, v67
    v_cvt_pk_bf16_f32 v102, v68, v69
    v_cvt_pk_bf16_f32 v103, v70, v71
    buffer_store_dwordx4 v[100:103], v5, s[4:7], 0 offen offset:256 sc1
    v_pk_mul_f32 v[72:73], v[72:73], v[12:13] op_sel_hi:[1,0]
    v_pk_mul_f32 v[74:75], v[74:75], v[12:13] op_sel_hi:[1,0]
    v_pk_mul_f32 v[76:77], v[76:77], v[12:13] op_sel_hi:[1,0]
    v_pk_mul_f32 v[78:79], v[78:79], v[12:13] op_sel_hi:[1,0]
    v_cvt_pk_bf16_f32 v104, v72, v73
    v_cvt_pk_bf16_f32 v105, v74, v75
    v_cvt_pk_bf16_f32 v106, v76, v77
    v_cvt_pk_bf16_f32 v107, v78, v79
    buffer_store_dwordx4 v[104:107], v5, s[4:7], 0 offen offset:512 sc1
    v_pk_mul_f32 v[80:81], v[80:81], v[12:13] op_sel_hi:[1,0]
    v_pk_mul_f32 v[82:83], v[82:83], v[12:13] op_sel_hi:[1,0]
    v_pk_mul_f32 v[84:85], v[84:85], v[12:13] op_sel_hi:[1,0]
    v_pk_mul_f32 v[86:87], v[86:87], v[12:13] op_sel_hi:[1,0]
    v_cvt_pk_bf16_f32 v108, v80, v81
    v_cvt_pk_bf16_f32 v109, v82, v83
    v_cvt_pk_bf16_f32 v110, v84, v85
    v_cvt_pk_bf16_f32 v111, v86, v87
    buffer_store_dwordx4 v[108:111], v5, s[4:7], 0 offen offset:768 sc1
    v_pk_mul_f32 v[88:89], v[88:89], v[12:13] op_sel_hi:[1,0]
    v_pk_mul_f32 v[90:91], v[90:91], v[12:13] op_sel_hi:[1,0]
    v_pk_mul_f32 v[92:93], v[92:93], v[12:13] op_sel_hi:[1,0]
    v_pk_mul_f32 v[94:95], v[94:95], v[12:13] op_sel_hi:[1,0]
    v_cvt_pk_bf16_f32 v112, v88, v89
    v_cvt_pk_bf16_f32 v113, v90, v91
    v_cvt_pk_bf16_f32 v114, v92, v93
    v_cvt_pk_bf16_f32 v115, v94, v95
    buffer_store_dwordx4 v[112:115], v5, s[4:7], 0 offen offset:1024 sc1
    s_barrier
    s_waitcnt vmcnt(5)
    v_dot2_f32_bf16 v9, v16, v36, 0
    v_dot2_f32_bf16 v8, v17, v37, 0
    v_dot2_f32_bf16 v9, v18, v38, v9
    v_dot2_f32_bf16 v8, v19, v39, v8
    v_dot2_f32_bf16 v9, v20, v40, v9
    v_dot2_f32_bf16 v8, v21, v41, v8
    v_dot2_f32_bf16 v9, v22, v42, v9
    v_dot2_f32_bf16 v8, v23, v43, v8
    v_dot2_f32_bf16 v9, v24, v44, v9
    v_dot2_f32_bf16 v8, v25, v45, v8
    v_dot2_f32_bf16 v9, v26, v46, v9
    v_dot2_f32_bf16 v8, v27, v47, v8
    v_dot2_f32_bf16 v9, v28, v48, v9
    v_dot2_f32_bf16 v8, v29, v49, v8
    v_dot2_f32_bf16 v9, v30, v50, v9
    v_dot2_f32_bf16 v8, v31, v51, v8
    v_dot2_f32_bf16 v9, v32, v52, v9
    v_dot2_f32_bf16 v8, v33, v53, v8
    v_dot2_f32_bf16 v9, v34, v54, v9
    v_dot2_f32_bf16 v8, v35, v55, v8
    s_nop 2
    v_add_f32 v9, v9, v8
    s_nop 1
    v_add_f32_dpp v9, v9, v9 row_ror:8 row_mask:0xf bank_mask:0xf
    s_nop 1
    v_add_f32_dpp v9, v9, v9 row_ror:4 row_mask:0xf bank_mask:0xf
    s_nop 1
    v_add_f32_dpp v9, v9, v9 row_ror:2 row_mask:0xf bank_mask:0xf
    s_nop 1
    v_add_f32_dpp v9, v9, v9 row_ror:1 row_mask:0xf bank_mask:0xf
    v_mul_f32 v9, 0xbfb8aa3b, v9
    v_exp_f32 v9, v9
    s_nop 0
    v_add_f32 v9, 1.0, v9
    v_rcp_f32 v8, v9
    v_lshlrev_b32 v10, 3, v10
    s_waitcnt lgkmcnt(0)
    s_mul_i32 s48, s48, 1664525
    s_add_u32 s48, s48, 1013904223
    v_mov_b32 v9, s48
    s_mov_b32 exec_lo, 0x00010001
    s_mov_b32 exec_hi, 0x00010001
    buffer_store_dwordx2 v[8:9], v10, s[8:11], 0 offen sc1
    s_mov_b64 exec, -1
    s_lshl_b32 s22, s19, 7
    v_lshl_add_u32 v10, v1, 15, s22
    s_waitcnt vmcnt(1)
    s_mov_b64 exec, 1
    v_mov_b32 v2, 163776
    v_mov_b32 v3, 1
    ds_add_rtn_u32 v3, v2, v3
    s_waitcnt lgkmcnt(0)
    v_readfirstlane_b32 s22, v3
    s_mov_b64 exec, 15
    s_cmp_lg_u32 s22, 3
    s_cbranch_scc1 Lpub12
    v_mov_b32 v3, s48
    buffer_store_dword v3, v10, s[44:47], 0 offen sc1
Lpub12:
    s_mov_b64 exec, -1
    s_cmp_ge_u32 s53, 30
    s_cbranch_scc1 Lsp_cons
    s_load_dwordx2 s[24:25], s[0:1], 40
    s_and_b32 s22, s3, 1
    s_lshr_b32 s23, s3, 1
    s_lshl_b32 s26, s16, 8
    s_lshl_b32 s27, s22, 7
    s_add_u32 s26, s26, s27
    v_lshrrev_b32 v2, 4, v1
    v_lshl_add_u32 v3, v2, 3, s26
    s_waitcnt lgkmcnt(0)
    s_mov_b32 s26, 3072
    s_mov_b32 s27, 0x20000
    s_add_u32 s8, s20, 5242880
    s_addc_u32 s9, s21, 0
    s_mov_b32 s10, 2785280
    s_mov_b32 s11, 0x20000
    buffer_load_dwordx2 v[48:49], v3, s[24:27], 0 offen offset:0
    buffer_load_dwordx2 v[50:51], v3, s[24:27], 0 offen offset:32
    buffer_load_dwordx2 v[52:53], v3, s[24:27], 0 offen offset:64
    buffer_load_dwordx2 v[54:55], v3, s[24:27], 0 offen offset:96
    s_setprio 0
    v_lshrrev_b32 v5, 2, v1
    v_and_b32 v6, 3, v1
    v_lshlrev_b32 v6, 3, v6
    v_and_b32 v7, 7, v5
    v_lshl_add_u32 v4, v5, 8, v6
    s_lshl_b32 s27, s22, 2
    s_add_u32 s28, s27, 0
    v_xor_b32 v2, s28, v7
    v_lshl_add_u32 v8, v2, 5, v4
    s_add_u32 s28, s27, 1
    v_xor_b32 v2, s28, v7
    v_lshl_add_u32 v9, v2, 5, v4
    s_add_u32 s28, s27, 2
    v_xor_b32 v2, s28, v7
    v_lshl_add_u32 v10, v2, 5, v4
    s_add_u32 s28, s27, 3
    v_xor_b32 v2, s28, v7
    v_lshl_add_u32 v11, v2, 5, v4
    v_lshrrev_b32 v7, 1, v5
    v_and_b32 v7, 3, v7
    v_lshl_add_u32 v4, v5, 7, v6
    v_add_u32 v4, 16384, v4
    s_lshl_b32 s27, s23, 1
    s_add_u32 s28, s27, 0
    v_xor_b32 v2, s28, v7
    v_lshl_add_u32 v12, v2, 5, v4
    s_add_u32 s28, s27, 1
    v_xor_b32 v2, s28, v7
    v_lshl_add_u32 v13, v2, 5, v4
    s_lshl_b32 s28, s17, 2
    s_add_u32 s28, s28, s27
    s_mul_i32 s28, s28, 68
    s_lshl_b32 s29, s16, 2
    s_add_u32 s28, s28, s29
    s_lshl_b32 s29, s22, 1
    s_add_u32 s28, s28, s29
    s_lshl_b32 s28, s28, 10
    v_lshl_add_u32 v14, v1, 4, s28
    s_lshl_b32 s28, s17, 4
    s_add_u32 s28, s28, s16
    s_lshl_b32 s28, s28, 7
    s_add_u32 s28, s28, 163840
    v_mul_u32_u24 v15, 20480, v1
    v_add_u32 v15, s28, v15
    s_mov_b32 s31, 0xffff0000
    s_waitcnt vmcnt(0)
    v_lshlrev_b32 v16, 16, v48
    v_and_b32 v17, s31, v48
    v_lshlrev_b32 v18, 16, v49
    v_and_b32 v19, s31, v49
    v_lshlrev_b32 v20, 16, v48
    v_and_b32 v21, s31, v48
    v_lshlrev_b32 v22, 16, v49
    v_and_b32 v23, s31, v49
    v_lshlrev_b32 v24, 16, v50
    v_and_b32 v25, s31, v50
    v_lshlrev_b32 v26, 16, v51
    v_and_b32 v27, s31, v51
    v_lshlrev_b32 v28, 16, v50
    v_and_b32 v29, s31, v50
    v_lshlrev_b32 v30, 16, v51
    v_and_b32 v31, s31, v51
    v_lshlrev_b32 v32, 16, v52
    v_and_b32 v33, s31, v52
    v_lshlrev_b32 v34, 16, v53
    v_and_b32 v35, s31, v53
    v_lshlrev_b32 v36, 16, v52
    v_and_b32 v37, s31, v52
    v_lshlrev_b32 v38, 16, v53
    v_and_b32 v39, s31, v53
    v_lshlrev_b32 v40, 16, v54
    v_and_b32 v41, s31, v54
    v_lshlrev_b32 v42, 16, v55
    v_and_b32 v43, s31, v55
    v_lshlrev_b32 v44, 16, v54
    v_and_b32 v45, s31, v54
    v_lshlrev_b32 v46, 16, v55
    v_and_b32 v47, s31, v55
    s_mov_b32 s33, 0
    s_mov_b32 s37, 0
    s_barrier
    ds_read_b64_tr_b16 v[48:49], v12 offset:0
    ds_read_b64_tr_b16 v[50:51], v12 offset:2048
    ds_read_b64_tr_b16 v[52:53], v13 offset:0
    ds_read_b64_tr_b16 v[54:55], v13 offset:2048
    ds_read_b64_tr_b16 v[56:57], v8 offset:0
    ds_read_b64_tr_b16 v[58:59], v8 offset:4096
    ds_read_b64_tr_b16 v[60:61], v9 offset:0
    ds_read_b64_tr_b16 v[62:63], v9 offset:4096
    ds_read_b64_tr_b16 v[64:65], v10 offset:0
    ds_read_b64_tr_b16 v[66:67], v10 offset:4096
    ds_read_b64_tr_b16 v[68:69], v11 offset:0
    ds_read_b64_tr_b16 v[70:71], v11 offset:4096
    ds_read_b64_tr_b16 v[72:73], v12 offset:4096
    ds_read_b64_tr_b16 v[74:75], v12 offset:6144
    ds_read_b64_tr_b16 v[76:77], v13 offset:4096
    ds_read_b64_tr_b16 v[78:79], v13 offset:6144
    ds_read_b64_tr_b16 v[80:81], v8 offset:8192
    ds_read_b64_tr_b16 v[82:83], v8 offset:12288
    ds_read_b64_tr_b16 v[84:85], v9 offset:8192
    ds_read_b64_tr_b16 v[86:87], v9 offset:12288
    ds_read_b64_tr_b16 v[88:89], v10 offset:8192
    ds_read_b64_tr_b16 v[90:91], v10 offset:12288
    ds_read_b64_tr_b16 v[92:93], v11 offset:8192
    ds_read_b64_tr_b16 v[94:95], v11 offset:12288
    s_add_u32 s40, s37, 24576
    s_cmp_ge_u32 s40, 147456
    s_cselect_b32 s41, 0, s40
    s_sub_u32 s40, s41, s37
    s_mov_b32 s37, s41
    v_add_u32 v8, s40, v8
    v_add_u32 v9, s40, v9
    v_add_u32 v10, s40, v10
    v_add_u32 v11, s40, v11
    v_add_u32 v12, s40, v12
    v_add_u32 v13, s40, v13
.p2align 3
Lg1_c:
    s_barrier
    ds_read_b64_tr_b16 v[96:97], v12 offset:0
    ds_read_b64_tr_b16 v[98:99], v12 offset:2048
    s_waitcnt lgkmcnt(2)
    v_mfma_f32_16x16x32_bf16 v[16:19], v[56:59], v[48:51], v[16:19]
    ds_read_b64_tr_b16 v[100:101], v13 offset:0
    ds_read_b64_tr_b16 v[102:103], v13 offset:2048
    v_mfma_f32_16x16x32_bf16 v[20:23], v[56:59], v[52:55], v[20:23]
    ds_read_b64_tr_b16 v[104:105], v8 offset:0
    ds_read_b64_tr_b16 v[106:107], v8 offset:4096
    v_mfma_f32_16x16x32_bf16 v[24:27], v[60:63], v[48:51], v[24:27]
    ds_read_b64_tr_b16 v[108:109], v9 offset:0
    ds_read_b64_tr_b16 v[110:111], v9 offset:4096
    v_mfma_f32_16x16x32_bf16 v[28:31], v[60:63], v[52:55], v[28:31]
    ds_read_b64_tr_b16 v[112:113], v10 offset:0
    ds_read_b64_tr_b16 v[114:115], v10 offset:4096
    v_mfma_f32_16x16x32_bf16 v[32:35], v[64:67], v[48:51], v[32:35]
    ds_read_b64_tr_b16 v[116:117], v11 offset:0
    ds_read_b64_tr_b16 v[118:119], v11 offset:4096
    v_mfma_f32_16x16x32_bf16 v[36:39], v[64:67], v[52:55], v[36:39]
    ds_read_b64_tr_b16 v[120:121], v12 offset:4096
    ds_read_b64_tr_b16 v[122:123], v12 offset:6144
    v_mfma_f32_16x16x32_bf16 v[40:43], v[68:71], v[48:51], v[40:43]
    ds_read_b64_tr_b16 v[124:125], v13 offset:4096
    ds_read_b64_tr_b16 v[126:127], v13 offset:6144
    v_mfma_f32_16x16x32_bf16 v[44:47], v[68:71], v[52:55], v[44:47]
    ds_read_b64_tr_b16 v[128:129], v8 offset:8192
    ds_read_b64_tr_b16 v[130:131], v8 offset:12288
    v_mfma_f32_16x16x32_bf16 v[16:19], v[80:83], v[72:75], v[16:19]
    ds_read_b64_tr_b16 v[132:133], v9 offset:8192
    ds_read_b64_tr_b16 v[134:135], v9 offset:12288
    v_mfma_f32_16x16x32_bf16 v[20:23], v[80:83], v[76:79], v[20:23]
    ds_read_b64_tr_b16 v[136:137], v10 offset:8192
    ds_read_b64_tr_b16 v[138:139], v10 offset:12288
    v_mfma_f32_16x16x32_bf16 v[24:27], v[84:87], v[72:75], v[24:27]
    ds_read_b64_tr_b16 v[140:141], v11 offset:8192
    ds_read_b64_tr_b16 v[142:143], v11 offset:12288
    v_mfma_f32_16x16x32_bf16 v[28:31], v[84:87], v[76:79], v[28:31]
    s_add_u32 s40, s37, 24576
    s_cmp_ge_u32 s40, 147456
    v_mfma_f32_16x16x32_bf16 v[32:35], v[88:91], v[72:75], v[32:35]
    s_cselect_b32 s41, 0, s40
    s_sub_u32 s40, s41, s37
    v_mfma_f32_16x16x32_bf16 v[36:39], v[88:91], v[76:79], v[36:39]
    s_mov_b32 s37, s41
    v_add_u32 v8, s40, v8
    v_mfma_f32_16x16x32_bf16 v[40:43], v[92:95], v[72:75], v[40:43]
    v_add_u32 v9, s40, v9
    v_add_u32 v10, s40, v10
    v_mfma_f32_16x16x32_bf16 v[44:47], v[92:95], v[76:79], v[44:47]
    v_add_u32 v11, s40, v11
    v_add_u32 v12, s40, v12
    v_add_u32 v13, s40, v13
    s_add_u32 s33, s33, 2
    s_cmp_ge_u32 s33, 32
    s_cbranch_scc1 Lg1_clast
    s_barrier
    ds_read_b64_tr_b16 v[48:49], v12 offset:0
    ds_read_b64_tr_b16 v[50:51], v12 offset:2048
    s_waitcnt lgkmcnt(2)
    v_mfma_f32_16x16x32_bf16 v[16:19], v[104:107], v[96:99], v[16:19]
    ds_read_b64_tr_b16 v[52:53], v13 offset:0
    ds_read_b64_tr_b16 v[54:55], v13 offset:2048
    v_mfma_f32_16x16x32_bf16 v[20:23], v[104:107], v[100:103], v[20:23]
    ds_read_b64_tr_b16 v[56:57], v8 offset:0
    ds_read_b64_tr_b16 v[58:59], v8 offset:4096
    v_mfma_f32_16x16x32_bf16 v[24:27], v[108:111], v[96:99], v[24:27]
    ds_read_b64_tr_b16 v[60:61], v9 offset:0
    ds_read_b64_tr_b16 v[62:63], v9 offset:4096
    v_mfma_f32_16x16x32_bf16 v[28:31], v[108:111], v[100:103], v[28:31]
    ds_read_b64_tr_b16 v[64:65], v10 offset:0
    ds_read_b64_tr_b16 v[66:67], v10 offset:4096
    v_mfma_f32_16x16x32_bf16 v[32:35], v[112:115], v[96:99], v[32:35]
    ds_read_b64_tr_b16 v[68:69], v11 offset:0
    ds_read_b64_tr_b16 v[70:71], v11 offset:4096
    v_mfma_f32_16x16x32_bf16 v[36:39], v[112:115], v[100:103], v[36:39]
    ds_read_b64_tr_b16 v[72:73], v12 offset:4096
    ds_read_b64_tr_b16 v[74:75], v12 offset:6144
    v_mfma_f32_16x16x32_bf16 v[40:43], v[116:119], v[96:99], v[40:43]
    ds_read_b64_tr_b16 v[76:77], v13 offset:4096
    ds_read_b64_tr_b16 v[78:79], v13 offset:6144
    v_mfma_f32_16x16x32_bf16 v[44:47], v[116:119], v[100:103], v[44:47]
    ds_read_b64_tr_b16 v[80:81], v8 offset:8192
    ds_read_b64_tr_b16 v[82:83], v8 offset:12288
    v_mfma_f32_16x16x32_bf16 v[16:19], v[128:131], v[120:123], v[16:19]
    ds_read_b64_tr_b16 v[84:85], v9 offset:8192
    ds_read_b64_tr_b16 v[86:87], v9 offset:12288
    v_mfma_f32_16x16x32_bf16 v[20:23], v[128:131], v[124:127], v[20:23]
    ds_read_b64_tr_b16 v[88:89], v10 offset:8192
    ds_read_b64_tr_b16 v[90:91], v10 offset:12288
    v_mfma_f32_16x16x32_bf16 v[24:27], v[132:135], v[120:123], v[24:27]
    ds_read_b64_tr_b16 v[92:93], v11 offset:8192
    ds_read_b64_tr_b16 v[94:95], v11 offset:12288
    v_mfma_f32_16x16x32_bf16 v[28:31], v[132:135], v[124:127], v[28:31]
    s_add_u32 s40, s37, 24576
    s_cmp_ge_u32 s40, 147456
    v_mfma_f32_16x16x32_bf16 v[32:35], v[136:139], v[120:123], v[32:35]
    s_cselect_b32 s41, 0, s40
    s_sub_u32 s40, s41, s37
    v_mfma_f32_16x16x32_bf16 v[36:39], v[136:139], v[124:127], v[36:39]
    s_mov_b32 s37, s41
    v_add_u32 v8, s40, v8
    v_mfma_f32_16x16x32_bf16 v[40:43], v[140:143], v[120:123], v[40:43]
    v_add_u32 v9, s40, v9
    v_add_u32 v10, s40, v10
    v_mfma_f32_16x16x32_bf16 v[44:47], v[140:143], v[124:127], v[44:47]
    v_add_u32 v11, s40, v11
    v_add_u32 v12, s40, v12
    v_add_u32 v13, s40, v13
    s_branch Lg1_c
Lg1_clast:
    s_waitcnt lgkmcnt(0)
    v_mfma_f32_16x16x32_bf16 v[16:19], v[104:107], v[96:99], v[16:19]
    v_mfma_f32_16x16x32_bf16 v[24:27], v[108:111], v[96:99], v[24:27]
    v_mfma_f32_16x16x32_bf16 v[16:19], v[128:131], v[120:123], v[16:19]
    v_mfma_f32_16x16x32_bf16 v[24:27], v[132:135], v[120:123], v[24:27]
    v_mfma_f32_16x16x32_bf16 v[20:23], v[104:107], v[100:103], v[20:23]
    v_mfma_f32_16x16x32_bf16 v[28:31], v[108:111], v[100:103], v[28:31]
    v_mfma_f32_16x16x32_bf16 v[20:23], v[128:131], v[124:127], v[20:23]
    v_mfma_f32_16x16x32_bf16 v[28:31], v[132:135], v[124:127], v[28:31]
    v_mov_b32 v2, 0xc0135761
    v_mov_b32 v4, 0xbdd2d3e8
    v_mov_b32 v6, 1.0
    s_setprio 2
    v_pk_mul_f32 v[48:49], v[16:17], v[16:17]
    v_mfma_f32_16x16x32_bf16 v[32:35], v[112:115], v[96:99], v[32:35]
    v_pk_mul_f32 v[50:51], v[18:19], v[18:19]
    v_mfma_f32_16x16x32_bf16 v[40:43], v[116:119], v[96:99], v[40:43]
    v_pk_mul_f32 v[52:53], v[24:25], v[24:25]
    v_mfma_f32_16x16x32_bf16 v[32:35], v[136:139], v[120:123], v[32:35]
    v_pk_mul_f32 v[54:55], v[26:27], v[26:27]
    v_mfma_f32_16x16x32_bf16 v[40:43], v[140:143], v[120:123], v[40:43]
    v_pk_fma_f32 v[48:49], v[48:49], v[4:5], v[2:3] op_sel_hi:[1,0,0]
    v_mfma_f32_16x16x32_bf16 v[36:39], v[112:115], v[100:103], v[36:39]
    v_pk_fma_f32 v[50:51], v[50:51], v[4:5], v[2:3] op_sel_hi:[1,0,0]
    v_mfma_f32_16x16x32_bf16 v[44:47], v[116:119], v[100:103], v[44:47]
    v_pk_fma_f32 v[52:53], v[52:53], v[4:5], v[2:3] op_sel_hi:[1,0,0]
    v_mfma_f32_16x16x32_bf16 v[36:39], v[136:139], v[124:127], v[36:39]
    v_pk_fma_f32 v[54:55], v[54:55], v[4:5], v[2:3] op_sel_hi:[1,0,0]
    v_mfma_f32_16x16x32_bf16 v[44:47], v[140:143], v[124:127], v[44:47]
    v_pk_mul_f32 v[48:49], v[48:49], v[16:17]
    v_pk_mul_f32 v[50:51], v[50:51], v[18:19]
    v_pk_mul_f32 v[52:53], v[52:53], v[24:25]
    v_pk_mul_f32 v[54:55], v[54:55], v[26:27]
    v_exp_f32 v48, v48
    v_exp_f32 v49, v49
    v_exp_f32 v50, v50
    v_exp_f32 v51, v51
    v_exp_f32 v52, v52
    v_exp_f32 v53, v53
    v_exp_f32 v54, v54
    v_exp_f32 v55, v55
    v_pk_add_f32 v[48:49], v[48:49], v[6:7] op_sel_hi:[1,0]
    v_pk_add_f32 v[50:51], v[50:51], v[6:7] op_sel_hi:[1,0]
    v_pk_add_f32 v[52:53], v[52:53], v[6:7] op_sel_hi:[1,0]
    v_pk_add_f32 v[54:55], v[54:55], v[6:7] op_sel_hi:[1,0]
    v_rcp_f32 v48, v48
    v_rcp_f32 v49, v49
    v_rcp_f32 v50, v50
    v_rcp_f32 v51, v51
    v_rcp_f32 v52, v52
    v_rcp_f32 v53, v53
    v_rcp_f32 v54, v54
    v_rcp_f32 v55, v55
    v_pk_mul_f32 v[48:49], v[48:49], v[16:17]
    v_pk_mul_f32 v[50:51], v[50:51], v[18:19]
    v_pk_mul_f32 v[52:53], v[52:53], v[24:25]
    v_pk_mul_f32 v[54:55], v[54:55], v[26:27]
    v_cvt_pk_bf16_f32 v72, v48, v49
    v_cvt_pk_bf16_f32 v73, v50, v51
    v_cvt_pk_bf16_f32 v74, v52, v53
    v_cvt_pk_bf16_f32 v75, v54, v55
    s_mov_b32 s29, 0
    buffer_store_dwordx4 v[72:75], v14, s[8:11], s29 offen offset:0 sc1
    v_pk_mul_f32 v[48:49], v[20:21], v[20:21]
    v_pk_mul_f32 v[50:51], v[22:23], v[22:23]
    v_pk_mul_f32 v[52:53], v[28:29], v[28:29]
    v_pk_mul_f32 v[54:55], v[30:31], v[30:31]
    v_pk_fma_f32 v[48:49], v[48:49], v[4:5], v[2:3] op_sel_hi:[1,0,0]
    v_pk_fma_f32 v[50:51], v[50:51], v[4:5], v[2:3] op_sel_hi:[1,0,0]
    v_pk_fma_f32 v[52:53], v[52:53], v[4:5], v[2:3] op_sel_hi:[1,0,0]
    v_pk_fma_f32 v[54:55], v[54:55], v[4:5], v[2:3] op_sel_hi:[1,0,0]
    v_pk_mul_f32 v[48:49], v[48:49], v[20:21]
    v_pk_mul_f32 v[50:51], v[50:51], v[22:23]
    v_pk_mul_f32 v[52:53], v[52:53], v[28:29]
    v_pk_mul_f32 v[54:55], v[54:55], v[30:31]
    v_exp_f32 v48, v48
    v_exp_f32 v49, v49
    v_exp_f32 v50, v50
    v_exp_f32 v51, v51
    v_exp_f32 v52, v52
    v_exp_f32 v53, v53
    v_exp_f32 v54, v54
    v_exp_f32 v55, v55
    v_pk_add_f32 v[48:49], v[48:49], v[6:7] op_sel_hi:[1,0]
    v_pk_add_f32 v[50:51], v[50:51], v[6:7] op_sel_hi:[1,0]
    v_pk_add_f32 v[52:53], v[52:53], v[6:7] op_sel_hi:[1,0]
    v_pk_add_f32 v[54:55], v[54:55], v[6:7] op_sel_hi:[1,0]
    v_rcp_f32 v48, v48
    v_rcp_f32 v49, v49
    v_rcp_f32 v50, v50
    v_rcp_f32 v51, v51
    v_rcp_f32 v52, v52
    v_rcp_f32 v53, v53
    v_rcp_f32 v54, v54
    v_rcp_f32 v55, v55
    v_pk_mul_f32 v[48:49], v[48:49], v[20:21]
    v_pk_mul_f32 v[50:51], v[50:51], v[22:23]
    v_pk_mul_f32 v[52:53], v[52:53], v[28:29]
    v_pk_mul_f32 v[54:55], v[54:55], v[30:31]
    v_cvt_pk_bf16_f32 v76, v48, v49
    v_cvt_pk_bf16_f32 v77, v50, v51
    v_cvt_pk_bf16_f32 v78, v52, v53
    v_cvt_pk_bf16_f32 v79, v54, v55
    s_mov_b32 s29, 69632
    buffer_store_dwordx4 v[76:79], v14, s[8:11], s29 offen offset:0 sc1
    v_pk_mul_f32 v[48:49], v[32:33], v[32:33]
    v_pk_mul_f32 v[50:51], v[34:35], v[34:35]
    v_pk_mul_f32 v[52:53], v[40:41], v[40:41]
    v_pk_mul_f32 v[54:55], v[42:43], v[42:43]
    v_pk_fma_f32 v[48:49], v[48:49], v[4:5], v[2:3] op_sel_hi:[1,0,0]
    v_pk_fma_f32 v[50:51], v[50:51], v[4:5], v[2:3] op_sel_hi:[1,0,0]
    v_pk_fma_f32 v[52:53], v[52:53], v[4:5], v[2:3] op_sel_hi:[1,0,0]
    v_pk_fma_f32 v[54:55], v[54:55], v[4:5], v[2:3] op_sel_hi:[1,0,0]
    v_pk_mul_f32 v[48:49], v[48:49], v[32:33]
    v_pk_mul_f32 v[50:51], v[50:51], v[34:35]
    v_pk_mul_f32 v[52:53], v[52:53], v[40:41]
    v_pk_mul_f32 v[54:55], v[54:55], v[42:43]
    v_exp_f32 v48, v48
    v_exp_f32 v49, v49
    v_exp_f32 v50, v50
    v_exp_f32 v51, v51
    v_exp_f32 v52, v52
    v_exp_f32 v53, v53
    v_exp_f32 v54, v54
    v_exp_f32 v55, v55
    v_pk_add_f32 v[48:49], v[48:49], v[6:7] op_sel_hi:[1,0]
    v_pk_add_f32 v[50:51], v[50:51], v[6:7] op_sel_hi:[1,0]
    v_pk_add_f32 v[52:53], v[52:53], v[6:7] op_sel_hi:[1,0]
    v_pk_add_f32 v[54:55], v[54:55], v[6:7] op_sel_hi:[1,0]
    v_rcp_f32 v48, v48
    v_rcp_f32 v49, v49
    v_rcp_f32 v50, v50
    v_rcp_f32 v51, v51
    v_rcp_f32 v52, v52
    v_rcp_f32 v53, v53
    v_rcp_f32 v54, v54
    v_rcp_f32 v55, v55
    v_pk_mul_f32 v[48:49], v[48:49], v[32:33]
    v_pk_mul_f32 v[50:51], v[50:51], v[34:35]
    v_pk_mul_f32 v[52:53], v[52:53], v[40:41]
    v_pk_mul_f32 v[54:55], v[54:55], v[42:43]
    v_cvt_pk_bf16_f32 v80, v48, v49
    v_cvt_pk_bf16_f32 v81, v50, v51
    v_cvt_pk_bf16_f32 v82, v52, v53
    v_cvt_pk_bf16_f32 v83, v54, v55
    s_mov_b32 s29, 0
    buffer_store_dwordx4 v[80:83], v14, s[8:11], s29 offen offset:1024 sc1
    v_pk_mul_f32 v[48:49], v[36:37], v[36:37]
    v_pk_mul_f32 v[50:51], v[38:39], v[38:39]
    v_pk_mul_f32 v[52:53], v[44:45], v[44:45]
    v_pk_mul_f32 v[54:55], v[46:47], v[46:47]
    v_pk_fma_f32 v[48:49], v[48:49], v[4:5], v[2:3] op_sel_hi:[1,0,0]
    v_pk_fma_f32 v[50:51], v[50:51], v[4:5], v[2:3] op_sel_hi:[1,0,0]
    v_pk_fma_f32 v[52:53], v[52:53], v[4:5], v[2:3] op_sel_hi:[1,0,0]
    v_pk_fma_f32 v[54:55], v[54:55], v[4:5], v[2:3] op_sel_hi:[1,0,0]
    v_pk_mul_f32 v[48:49], v[48:49], v[36:37]
    v_pk_mul_f32 v[50:51], v[50:51], v[38:39]
    v_pk_mul_f32 v[52:53], v[52:53], v[44:45]
    v_pk_mul_f32 v[54:55], v[54:55], v[46:47]
    v_exp_f32 v48, v48
    v_exp_f32 v49, v49
    v_exp_f32 v50, v50
    v_exp_f32 v51, v51
    v_exp_f32 v52, v52
    v_exp_f32 v53, v53
    v_exp_f32 v54, v54
    v_exp_f32 v55, v55
    v_pk_add_f32 v[48:49], v[48:49], v[6:7] op_sel_hi:[1,0]
    v_pk_add_f32 v[50:51], v[50:51], v[6:7] op_sel_hi:[1,0]
    v_pk_add_f32 v[52:53], v[52:53], v[6:7] op_sel_hi:[1,0]
    v_pk_add_f32 v[54:55], v[54:55], v[6:7] op_sel_hi:[1,0]
    v_rcp_f32 v48, v48
    v_rcp_f32 v49, v49
    v_rcp_f32 v50, v50
    v_rcp_f32 v51, v51
    v_rcp_f32 v52, v52
    v_rcp_f32 v53, v53
    v_rcp_f32 v54, v54
    v_rcp_f32 v55, v55
    v_pk_mul_f32 v[48:49], v[48:49], v[36:37]
    v_pk_mul_f32 v[50:51], v[50:51], v[38:39]
    v_pk_mul_f32 v[52:53], v[52:53], v[44:45]
    v_pk_mul_f32 v[54:55], v[54:55], v[46:47]
    v_cvt_pk_bf16_f32 v84, v48, v49
    v_cvt_pk_bf16_f32 v85, v50, v51
    v_cvt_pk_bf16_f32 v86, v52, v53
    v_cvt_pk_bf16_f32 v87, v54, v55
    s_mov_b32 s29, 69632
    buffer_store_dwordx4 v[84:87], v14, s[8:11], s29 offen offset:1024 sc1
    s_barrier
    s_waitcnt vmcnt(0)
    s_mov_b64 exec, 1
    v_mov_b32 v2, 163780
    v_mov_b32 v3, 1
    ds_add_rtn_u32 v3, v2, v3
    s_waitcnt lgkmcnt(0)
    v_readfirstlane_b32 s22, v3
    s_mov_b64 exec, 15
    s_cmp_lg_u32 s22, 3
    s_cbranch_scc1 Lpub13
    v_mov_b32 v3, s48
    buffer_store_dword v3, v15, s[44:47], 0 offen sc1
Lpub13:
    s_mov_b64 exec, -1
    s_branch Lp2_c0
Lsp_cons:
    s_barrier
    s_cmp_ge_u32 s3, 2
    s_cbranch_scc1 Lc3_d
    s_load_dwordx2 s[12:13], s[0:1], 48
    s_lshr_b32 s22, s50, 1
    s_lshl_b32 s22, s22, 11
    s_add_u32 s22, s22, 131072
    v_mov_b32 v12, s22
    s_mov_b32 s49, 0
    s_mov_b32 exec_lo, 1
    s_mov_b32 exec_hi, 0
Lg14:
    buffer_load_dword v2, v12, s[44:47], 0 offen sc1
    s_waitcnt vmcnt(0)
    v_xor_b32 v2, s48, v2
    v_cmp_ne_u32 vcc, 0, v2
    s_add_u32 s49, s49, 1
    s_cmp_eq_u64 vcc, 0
    s_cbranch_scc1 Lg14d
    s_sleep 8
    s_cmp_lt_u32 s49, 20000
    s_cbranch_scc1 Lg14
Lg14d:
    s_mov_b64 exec, -1
    s_and_b32 s22, s53, 1
    s_mul_i32 s22, s22, 2
    s_add_u32 s22, s22, s3
    s_lshl_b32 s22, s22, 6
    v_add_u32 v2, s22, v1
    v_lshlrev_b32 v2, 12, v2
    s_lshr_b32 s22, s52, 1
    s_lshl_b32 s22, s22, 10
    s_add_u32 s22, s22, 1573248
    s_mov_b32 s33, 0
    s_waitcnt lgkmcnt(0)
    s_mov_b32 s14, 6291456
    s_mov_b32 s15, 0x20000
Lc3_l:
    buffer_load_dword v30, v2, s[12:15], s22 offen
    s_add_u32 s22, s22, 1048576
    s_add_u32 s33, s33, 1
    s_cmp_lt_u32 s33, 3
    s_waitcnt vmcnt(0)
    s_cbranch_scc1 Lc3_l
Lc3_d:
    s_lshl_b32 s22, s3, 8
    s_add_u32 s22, s22, s2
    s_cmp_lg_u32 s22, 240
    s_cbranch_scc1 Lp2_c0
    v_lshlrev_b32 v12, 7, v1
    s_mov_b32 s49, 0
    s_mov_b32 exec_lo, 4294967295
    s_mov_b32 exec_hi, 4294967295
Lg15:
    buffer_load_dword v2, v12, s[44:47], 0 offen sc1
    s_mov_b32 s22, 8192
    buffer_load_dword v3, v12, s[44:47], s22 offen sc1
    s_waitcnt vmcnt(0)
    v_xor_b32 v2, s48, v2
    v_xor_b32 v3, s48, v3
    v_or_b32 v2, v2, v3
    v_cmp_ne_u32 vcc, 0, v2
    s_add_u32 s49, s49, 1
    s_cmp_eq_u64 vcc, 0
    s_cbranch_scc1 Lg15d
    s_sleep 8
    s_cmp_lt_u32 s49, 20000
    s_cbranch_scc1 Lg15
Lg15d:
    s_mov_b64 exec, -1
    v_lshrrev_b32 v12, 3, v1
    v_lshlrev_b32 v12, 11, v12
    v_and_b32 v13, 7, v1
    v_lshl_add_u32 v12, v13, 7, v12
    v_add_u32 v12, 131072, v12
    s_mov_b32 s49, 0
    s_mov_b32 exec_lo, 4294967295
    s_mov_b32 exec_hi, 4294967295
Lg16:
    buffer_load_dword v2, v12, s[44:47], 0 offen sc1
    s_mov_b32 s22, 16384
    buffer_load_dword v3, v12, s[44:47], s22 offen sc1
    s_waitcnt vmcnt(0)
    v_xor_b32 v2, s48, v2
    v_xor_b32 v3, s48, v3
    v_or_b32 v2, v2, v3
    v_cmp_ne_u32 vcc, 0, v2
    s_add_u32 s49, s49, 1
    s_cmp_eq_u64 vcc, 0
    s_cbranch_scc1 Lg16d
    s_sleep 8
    s_cmp_lt_u32 s49, 20000
    s_cbranch_scc1 Lg16
Lg16d:
    s_mov_b64 exec, -1
    s_mov_b64 exec, 1
    v_mov_b32 v2, s48
    v_mov_b32 v3, 262144
    buffer_store_dword v2, v3, s[44:47], 0 offen sc1
    s_mov_b64 exec, -1
    s_branch Lp2_c0
Lrole_qa:
    s_and_b32 s54, s23, 0
    s_cselect_b32 s51, 5, 6
    s_cselect_b32 s27, 20, 16
    s_mul_i32 s51, s51, s26
    s_add_u32 s51, s51, s27
    s_and_b32 s16, s22, 1
    s_lshl_b32 s16, s16, 3
    s_add_u32 s16, s16, s23
    s_lshr_b32 s17, s22, 1
    s_lshl_b32 s17, s17, 2
    s_add_u32 s17, s17, s26
    s_xor_b32 s18, s26, s23
    s_and_b32 s18, s18, 1
    s_mul_i32 s18, s18, 5
    s_cmp_ge_u32 s3, 4
    s_cbranch_scc1 Lq_cons
    s_setprio 1
    s_cmp_eq_u32 s3, 3
    s_cbranch_scc1 Lq_idle
    s_load_dwordx2 s[4:5], s[0:1], 0
    s_load_dwordx2 s[8:9], s[0:1], 8
    s_waitcnt lgkmcnt(0)
    s_add_u32 s44, s20, 8454144
    s_addc_u32 s45, s21, 0
    s_mov_b32 s46, 458752
    s_mov_b32 s47, 0x20000
    s_load_dword s48, s[44:45], 262144
    v_lshrrev_b32 v2, 3, v1
    s_lshl_b32 s23, s3, 3
    v_add_u32 v2, s23, v2
    s_lshl_b32 s26, s16, 7
    s_sub_u32 s26, s26, 16
    v_and_b32 v3, 7, v1
    v_add_u32 v4, 0, v2
    v_lshrrev_b32 v5, 1, v4
    v_and_b32 v5, 7, v5
    v_xor_b32 v5, v5, v3
    v_add_u32 v4, s26, v4
    v_max_i32 v4, 0, v4
    v_mul_u32_u24 v4, 1280, v4
    v_lshl_add_u32 v8, v5, 4, v4
    v_add_u32 v4, 24, v2
    v_lshrrev_b32 v5, 1, v4
    v_and_b32 v5, 7, v5
    v_xor_b32 v5, v5, v3
    v_add_u32 v4, s26, v4
    v_max_i32 v4, 0, v4
    v_mul_u32_u24 v4, 1280, v4
    v_lshl_add_u32 v9, v5, 4, v4
    v_add_u32 v4, 48, v2
    v_lshrrev_b32 v5, 1, v4
    v_and_b32 v5, 7, v5
    v_xor_b32 v5, v5, v3
    v_add_u32 v4, s26, v4
    v_max_i32 v4, 0, v4
    v_mul_u32_u24 v4, 1280, v4
    v_lshl_add_u32 v10, v5, 4, v4
    v_add_u32 v4, 72, v2
    v_lshrrev_b32 v5, 1, v4
    v_and_b32 v5, 7, v5
    v_xor_b32 v5, v5, v3
    v_add_u32 v4, s26, v4
    v_max_i32 v4, 0, v4
    v_mul_u32_u24 v4, 1280, v4
    v_lshl_add_u32 v11, v5, 4, v4
    v_add_u32 v4, 96, v2
    v_lshrrev_b32 v5, 1, v4
    v_and_b32 v5, 7, v5
    v_xor_b32 v5, v5, v3
    v_add_u32 v4, s26, v4
    v_max_i32 v4, 0, v4
    v_mul_u32_u24 v4, 1280, v4
    v_lshl_add_u32 v12, v5, 4, v4
    v_add_u32 v4, 120, v2
    v_lshrrev_b32 v5, 1, v4
    v_and_b32 v5, 7, v5
    v_xor_b32 v5, v5, v3
    v_add_u32 v4, s26, v4
    v_max_i32 v4, 0, v4
    v_mul_u32_u24 v4, 1280, v4
    v_lshl_add_u32 v13, v5, 4, v4
    s_mul_i32 s23, s3, 320
    s_mul_i32 s26, s17, 160
    v_add_u32 v2, s23, v1
    v_add_u32 v3, 0, v2
    v_mul_u32_u24 v4, 2185, v3
    v_lshrrev_b32 v4, 16, v4
    v_mul_u32_u24 v5, 30, v4
    v_sub_u32 v3, v3, v5
    v_mul_u32_u24 v5, 26, v3
    v_lshrrev_b32 v5, 8, v5
    v_mul_u32_u24 v5, 1120, v5
    v_lshl_add_u32 v3, v3, 4, v5
    v_and_b32 v5, 12, v4
    v_lshlrev_b32 v5, 1, v5
    v_lshrrev_b32 v6, 4, v4
    v_lshl_add_u32 v5, v6, 2, v5
    v_and_b32 v4, 3, v4
    v_add_u32 v4, v4, v5
    v_mul_u32_u24 v4, 3840, v4
    v_add3_u32 v16, v4, v3, s26
    v_add_u32 v3, 64, v2
    v_mul_u32_u24 v4, 2185, v3
    v_lshrrev_b32 v4, 16, v4
    v_mul_u32_u24 v5, 30, v4
    v_sub_u32 v3, v3, v5
    v_mul_u32_u24 v5, 26, v3
    v_lshrrev_b32 v5, 8, v5
    v_mul_u32_u24 v5, 1120, v5
    v_lshl_add_u32 v3, v3, 4, v5
    v_and_b32 v5, 12, v4
    v_lshlrev_b32 v5, 1, v5
    v_lshrrev_b32 v6, 4, v4
    v_lshl_add_u32 v5, v6, 2, v5
    v_and_b32 v4, 3, v4
    v_add_u32 v4, v4, v5
    v_mul_u32_u24 v4, 3840, v4
    v_add3_u32 v17, v4, v3, s26
    v_add_u32 v3, 128, v2
    v_mul_u32_u24 v4, 2185, v3
    v_lshrrev_b32 v4, 16, v4
    v_mul_u32_u24 v5, 30, v4
    v_sub_u32 v3, v3, v5
    v_mul_u32_u24 v5, 26, v3
    v_lshrrev_b32 v5, 8, v5
    v_mul_u32_u24 v5, 1120, v5
    v_lshl_add_u32 v3, v3, 4, v5
    v_and_b32 v5, 12, v4
    v_lshlrev_b32 v5, 1, v5
    v_lshrrev_b32 v6, 4, v4
    v_lshl_add_u32 v5, v6, 2, v5
    v_and_b32 v4, 3, v4
    v_add_u32 v4, v4, v5
    v_mul_u32_u24 v4, 3840, v4
    v_add3_u32 v18, v4, v3, s26
    v_add_u32 v3, 192, v2
    v_mul_u32_u24 v4, 2185, v3
    v_lshrrev_b32 v4, 16, v4
    v_mul_u32_u24 v5, 30, v4
    v_sub_u32 v3, v3, v5
    v_mul_u32_u24 v5, 26, v3
    v_lshrrev_b32 v5, 8, v5
    v_mul_u32_u24 v5, 1120, v5
    v_lshl_add_u32 v3, v3, 4, v5
    v_and_b32 v5, 12, v4
    v_lshlrev_b32 v5, 1, v5
    v_lshrrev_b32 v6, 4, v4
    v_lshl_add_u32 v5, v6, 2, v5
    v_and_b32 v4, 3, v4
    v_add_u32 v4, v4, v5
    v_mul_u32_u24 v4, 3840, v4
    v_add3_u32 v19, v4, v3, s26
    v_add_u32 v3, 256, v2
    v_mul_u32_u24 v4, 2185, v3
    v_lshrrev_b32 v4, 16, v4
    v_mul_u32_u24 v5, 30, v4
    v_sub_u32 v3, v3, v5
    v_mul_u32_u24 v5, 26, v3
    v_lshrrev_b32 v5, 8, v5
    v_mul_u32_u24 v5, 1120, v5
    v_lshl_add_u32 v3, v3, 4, v5
    v_and_b32 v5, 12, v4
    v_lshlrev_b32 v5, 1, v5
    v_lshrrev_b32 v6, 4, v4
    v_lshl_add_u32 v5, v6, 2, v5
    v_and_b32 v4, 3, v4
    v_add_u32 v4, v4, v5
    v_mul_u32_u24 v4, 3840, v4
    v_add3_u32 v20, v4, v3, s26
    s_mov_b32 s34, s18
    s_mov_b32 s37, 0
    s_lshl_b32 s38, s3, 10
    s_mul_i32 s39, s3, 5120
    s_add_u32 s39, s39, 18432
    s_mov_b32 s33, 0
    s_mov_b32 s6, 2621440
    s_mov_b32 s7, 0x20000
    s_mov_b32 s10, 2457600
    s_mov_b32 s11, 0x20000
    s_lshl_b32 s40, s34, 7
    s_mul_i32 s41, s34, 245760
    s_add_u32 s42, s37, s38
    s_add_u32 s43, s37, s39
    s_add_u32 s36, s41, 122880
    s_add_u32 m0, s42, 0
    s_nop 0
    buffer_load_dwordx4 v8, s[4:7], s40 offen lds
    s_add_u32 m0, s42, 3072
    s_nop 0
    buffer_load_dwordx4 v9, s[4:7], s40 offen lds
    s_add_u32 m0, s42, 6144
    s_nop 0
    buffer_load_dwordx4 v10, s[4:7], s40 offen lds
    s_add_u32 m0, s43, 0
    s_nop 0
    buffer_load_dwordx4 v16, s[8:11], s41 offen lds
    s_add_u32 m0, s43, 1024
    s_nop 0
    buffer_load_dwordx4 v17, s[8:11], s41 offen lds
    s_add_u32 m0, s43, 2048
    s_nop 0
    buffer_load_dwordx4 v18, s[8:11], s41 offen lds
    s_add_u32 m0, s43, 3072
    s_nop 0
    buffer_load_dwordx4 v19, s[8:11], s41 offen lds
    s_add_u32 m0, s43, 4096
    s_nop 0
    buffer_load_dwordx4 v20, s[8:11], s41 offen lds
    s_add_u32 m0, s42, 9216
    s_nop 0
    buffer_load_dwordx4 v11, s[4:7], s40 offen lds
    s_add_u32 m0, s42, 12288
    s_nop 0
    buffer_load_dwordx4 v12, s[4:7], s40 offen lds
    s_add_u32 m0, s42, 15360
    s_nop 0
    buffer_load_dwordx4 v13, s[4:7], s40 offen lds
    s_add_u32 m0, s43, 15360
    s_nop 0
    buffer_load_dwordx4 v16, s[8:11], s36 offen lds
    s_add_u32 m0, s43, 16384
    s_nop 0
    buffer_load_dwordx4 v17, s[8:11], s36 offen lds
    s_add_u32 m0, s43, 17408
    s_nop 0
    buffer_load_dwordx4 v18, s[8:11], s36 offen lds
    s_add_u32 m0, s43, 18432
    s_nop 0
    buffer_load_dwordx4 v19, s[8:11], s36 offen lds
    s_add_u32 m0, s43, 19456
    s_nop 0
    buffer_load_dwordx4 v20, s[8:11], s36 offen lds
    s_add_u32 s37, s37, 49152
    s_cmp_ge_u32 s37, 147456
    s_cselect_b32 s37, 0, s37
    s_add_u32 s34, s34, 1
    s_cmp_ge_u32 s34, 10
    s_cselect_b32 s34, 0, s34
    s_lshl_b32 s40, s34, 7
    s_mul_i32 s41, s34, 245760
    s_add_u32 s42, s37, s38
    s_add_u32 s43, s37, s39
    s_add_u32 s36, s41, 122880
    s_add_u32 m0, s42, 0
    s_nop 0
    buffer_load_dwordx4 v8, s[4:7], s40 offen lds
    s_add_u32 m0, s42, 3072
    s_nop 0
    buffer_load_dwordx4 v9, s[4:7], s40 offen lds
    s_add_u32 m0, s42, 6144
    s_nop 0
    buffer_load_dwordx4 v10, s[4:7], s40 offen lds
    s_add_u32 m0, s43, 0
    s_nop 0
    buffer_load_dwordx4 v16, s[8:11], s41 offen lds
    s_add_u32 m0, s43, 1024
    s_nop 0
    buffer_load_dwordx4 v17, s[8:11], s41 offen lds
    s_add_u32 m0, s43, 2048
    s_nop 0
    buffer_load_dwordx4 v18, s[8:11], s41 offen lds
    s_add_u32 m0, s43, 3072
    s_nop 0
    buffer_load_dwordx4 v19, s[8:11], s41 offen lds
    s_add_u32 m0, s43, 4096
    s_nop 0
    buffer_load_dwordx4 v20, s[8:11], s41 offen lds
    s_waitcnt lgkmcnt(0)
    s_mul_i32 s48, s48, 1664525
    s_add_u32 s48, s48, 1013904223
    s_waitcnt vmcnt(8)
    s_barrier
    s_add_u32 m0, s42, 9216
    s_nop 0
    buffer_load_dwordx4 v11, s[4:7], s40 offen lds
    s_add_u32 m0, s42, 12288
    s_nop 0
    buffer_load_dwordx4 v12, s[4:7], s40 offen lds
    s_add_u32 m0, s42, 15360
    s_nop 0
    buffer_load_dwordx4 v13, s[4:7], s40 offen lds
    s_add_u32 m0, s43, 15360
    s_nop 0
    buffer_load_dwordx4 v16, s[8:11], s36 offen lds
    s_add_u32 m0, s43, 16384
    s_nop 0
    buffer_load_dwordx4 v17, s[8:11], s36 offen lds
    s_add_u32 m0, s43, 17408
    s_nop 0
    buffer_load_dwordx4 v18, s[8:11], s36 offen lds
    s_add_u32 m0, s43, 18432
    s_nop 0
    buffer_load_dwordx4 v19, s[8:11], s36 offen lds
    s_add_u32 m0, s43, 19456
    s_nop 0
    buffer_load_dwordx4 v20, s[8:11], s36 offen lds
    s_add_u32 s37, s37, 49152
    s_cmp_ge_u32 s37, 147456
    s_cselect_b32 s37, 0, s37
    s_add_u32 s34, s34, 1
    s_cmp_ge_u32 s34, 10
    s_cselect_b32 s34, 0, s34
    s_lshl_b32 s40, s34, 7
    s_mul_i32 s41, s34, 245760
    s_add_u32 s42, s37, s38
    s_add_u32 s43, s37, s39
    s_add_u32 s36, s41, 122880
    s_add_u32 m0, s42, 0
    s_nop 0
    buffer_load_dwordx4 v8, s[4:7], s40 offen lds
    s_add_u32 m0, s42, 3072
    s_nop 0
    buffer_load_dwordx4 v9, s[4:7], s40 offen lds
    s_add_u32 m0, s42, 6144
    s_nop 0
    buffer_load_dwordx4 v10, s[4:7], s40 offen lds
    s_add_u32 m0, s43, 0
    s_nop 0
    buffer_load_dwordx4 v16, s[8:11], s41 offen lds
    s_add_u32 m0, s43, 1024
    s_nop 0
    buffer_load_dwordx4 v17, s[8:11], s41 offen lds
    s_add_u32 m0, s43, 2048
    s_nop 0
    buffer_load_dwordx4 v18, s[8:11], s41 offen lds
    s_add_u32 m0, s43, 3072
    s_nop 0
    buffer_load_dwordx4 v19, s[8:11], s41 offen lds
    s_add_u32 m0, s43, 4096
    s_nop 0
    buffer_load_dwordx4 v20, s[8:11], s41 offen lds
    s_add_u32 m0, s42, 9216
    s_nop 0
    buffer_load_dwordx4 v11, s[4:7], s40 offen lds
    s_add_u32 m0, s42, 12288
    s_nop 0
    buffer_load_dwordx4 v12, s[4:7], s40 offen lds
    s_add_u32 m0, s42, 15360
    s_nop 0
    buffer_load_dwordx4 v13, s[4:7], s40 offen lds
    s_add_u32 m0, s43, 15360
    s_nop 0
    buffer_load_dwordx4 v16, s[8:11], s36 offen lds
    s_add_u32 m0, s43, 16384
    s_nop 0
    buffer_load_dwordx4 v17, s[8:11], s36 offen lds
    s_add_u32 m0, s43, 17408
    s_nop 0
    buffer_load_dwordx4 v18, s[8:11], s36 offen lds
    s_add_u32 m0, s43, 18432
    s_nop 0
    buffer_load_dwordx4 v19, s[8:11], s36 offen lds
    s_add_u32 m0, s43, 19456
    s_nop 0
    buffer_load_dwordx4 v20, s[8:11], s36 offen lds
    s_add_u32 s37, s37, 49152
    s_cmp_ge_u32 s37, 147456
    s_cselect_b32 s37, 0, s37
    s_add_u32 s34, s34, 1
    s_cmp_ge_u32 s34, 10
    s_cselect_b32 s34, 0, s34
    s_mov_b32 s33, 3
    s_load_dwordx2 s[24:25], s[0:1], 48
    v_lshrrev_b32 v2, 3, v1
    s_lshl_b32 s22, s53, 3
    v_add_u32 v2, s22, v2
    v_lshlrev_b32 v2, 12, v2
    v_and_b32 v3, 7, v1
    v_lshl_add_u32 v2, v3, 7, v2
    s_lshr_b32 s22, s52, 1
    s_lshl_b32 s22, s22, 10
    v_add_u32 v29, s22, v2
    s_waitcnt lgkmcnt(0)
    s_mov_b32 s26, 6291456
    s_mov_b32 s27, 0x20000
Ls17:
    s_waitcnt vmcnt(16)
    s_barrier
    s_lshl_b32 s40, s34, 7
    s_mul_i32 s41, s34, 245760
    s_add_u32 s42, s37, s38
    s_add_u32 s43, s37, s39
    s_add_u32 s36, s41, 122880
    s_add_u32 m0, s42, 0
    s_nop 0
    buffer_load_dwordx4 v8, s[4:7], s40 offen lds
    s_add_u32 m0, s42, 3072
    s_nop 0
    buffer_load_dwordx4 v9, s[4:7], s40 offen lds
    s_add_u32 m0, s42, 6144
    s_nop 0
    buffer_load_dwordx4 v10, s[4:7], s40 offen lds
    s_add_u32 m0, s43, 0
    s_nop 0
    buffer_load_dwordx4 v16, s[8:11], s41 offen lds
    s_add_u32 m0, s43, 1024
    s_nop 0
    buffer_load_dwordx4 v17, s[8:11], s41 offen lds
    s_add_u32 m0, s43, 2048
    s_nop 0
    buffer_load_dwordx4 v18, s[8:11], s41 offen lds
    s_add_u32 m0, s43, 3072
    s_nop 0
    buffer_load_dwordx4 v19, s[8:11], s41 offen lds
    s_add_u32 m0, s43, 4096
    s_nop 0
    buffer_load_dwordx4 v20, s[8:11], s41 offen lds
    s_add_u32 m0, s42, 9216
    s_nop 0
    buffer_load_dwordx4 v11, s[4:7], s40 offen lds
    s_add_u32 m0, s42, 12288
    s_nop 0
    buffer_load_dwordx4 v12, s[4:7], s40 offen lds
    s_add_u32 m0, s42, 15360
    s_nop 0
    buffer_load_dwordx4 v13, s[4:7], s40 offen lds
    s_add_u32 m0, s43, 15360
    s_nop 0
    buffer_load_dwordx4 v16, s[8:11], s36 offen lds
    s_add_u32 m0, s43, 16384
    s_nop 0
    buffer_load_dwordx4 v17, s[8:11], s36 offen lds
    s_add_u32 m0, s43, 17408
    s_nop 0
    buffer_load_dwordx4 v18, s[8:11], s36 offen lds
    s_add_u32 m0, s43, 18432
    s_nop 0
    buffer_load_dwordx4 v19, s[8:11], s36 offen lds
    s_add_u32 m0, s43, 19456
    s_nop 0
    buffer_load_dwordx4 v20, s[8:11], s36 offen lds
    s_add_u32 s37, s37, 49152
    s_cmp_ge_u32 s37, 147456
    s_cselect_b32 s37, 0, s37
    s_add_u32 s34, s34, 1
    s_cmp_ge_u32 s34, 10
    s_cselect_b32 s34, 0, s34
    s_add_u32 s33, s33, 1
    s_cmp_lt_u32 s33, 10
    s_cbranch_scc1 Ls17
    s_waitcnt vmcnt(16)
    s_barrier
    s_waitcnt vmcnt(0)
    s_barrier
    s_lshl_b32 s22, s3, 20
    buffer_load_dword v30, v29, s[24:27], s22 offen
    s_barrier
    s_cmp_ge_u32 s3, 2
    s_cbranch_scc1 Lp2_d1
    s_branch Lp2_s1
Lq_idle:
    s_load_dwordx2 s[4:5], s[0:1], 0
    s_load_dwordx2 s[8:9], s[0:1], 8
    s_waitcnt lgkmcnt(0)
    s_add_u32 s44, s20, 8454144
    s_addc_u32 s45, s21, 0
    s_mov_b32 s46, 458752
    s_mov_b32 s47, 0x20000
    s_load_dword s48, s[44:45], 262144
    s_lshr_b32 s22, s52, 1
    s_lshl_b32 s22, s22, 5
    s_add_u32 s22, s22, s53
    s_mul_i32 s26, s22, 22
    s_add_u32 s26, s26, 16384
    s_lshl_b32 s26, s26, 7
    s_lshl_b32 s22, s22, 13
    s_add_u32 s23, s22, 0x100000
    v_lshlrev_b32 v2, 7, v1
    s_mov_b32 s10, 2457600
    s_mov_b32 s11, 0x20000
    buffer_load_dword v40, v2, s[8:11], s22 offen
    buffer_load_dword v41, v2, s[8:11], s23 offen
    s_mov_b64 exec, 0x3fffff
    buffer_load_dword v42, v2, s[8:11], s26 offen
    s_mov_b64 exec, -1
    s_waitcnt lgkmcnt(0)
    s_mul_i32 s48, s48, 1664525
    s_add_u32 s48, s48, 1013904223
    s_load_dwordx2 s[24:25], s[0:1], 48
    v_lshrrev_b32 v2, 3, v1
    s_lshl_b32 s22, s53, 3
    v_add_u32 v2, s22, v2
    v_lshlrev_b32 v2, 12, v2
    v_and_b32 v3, 7, v1
    v_lshl_add_u32 v2, v3, 7, v2
    s_lshr_b32 s22, s52, 1
    s_lshl_b32 s22, s22, 10
    v_add_u32 v29, s22, v2
    s_waitcnt lgkmcnt(0)
    s_mov_b32 s26, 6291456
    s_mov_b32 s27, 0x20000
    s_barrier
    s_barrier
    s_barrier
    s_barrier
    s_barrier
    s_barrier
    s_barrier
    s_barrier
    s_barrier
    s_barrier
    s_mov_b32 s22, 4194304
    buffer_load_dword v30, v29, s[24:27], s22 offen
    s_mov_b32 s22, 5242880
    buffer_load_dword v30, v29, s[24:27], s22 offen
    s_lshl_b32 s22, s3, 20
    buffer_load_dword v30, v29, s[24:27], s22 offen
    s_barrier
    s_branch Lp2_d1
Lq_cons:
    s_sub_u32 s3, s3, 4
    s_waitcnt lgkmcnt(0)
    s_add_u32 s44, s20, 8454144
    s_addc_u32 s45, s21, 0
    s_mov_b32 s46, 458752
    s_mov_b32 s47, 0x20000
    s_load_dword s48, s[44:45], 262144
    s_lshr_b32 s28, s3, 1
    s_and_b32 s29, s3, 1
    v_and_b32 v2, 15, v1
    v_lshrrev_b32 v3, 4, v1
    v_lshrrev_b32 v4, 1, v2
    v_xor_b32 v4, v4, v3
    v_lshlrev_b32 v4, 4, v4
    v_lshl_add_u32 v4, v2, 7, v4
    v_mov_b32 v8, v4
    v_xor_b32 v9, 64, v4
    v_lshrrev_b32 v5, 2, v1
    v_mul_u32_u24 v5, 480, v5
    s_mul_i32 s23, s29, 80
    s_add_u32 s23, s23, 18432
    v_add_u32 v5, s23, v5
    v_and_b32 v4, 3, v1
    v_lshl_add_u32 v10, v4, 3, v5
    v_and_b32 v6, 1, v1
    v_mul_u32_u24 v6, 40, v6
    v_add3_u32 v13, v6, v5, 32
    v_lshrrev_b32 v4, 1, v4
    v_mul_u32_u24 v4, 160, v4
    v_add_u32 v11, v4, v13
    v_mov_b32 v16, 0
    v_mov_b32 v17, 0
    v_mov_b32 v18, 0
    v_mov_b32 v19, 0
    v_mov_b32 v20, 0
    v_mov_b32 v21, 0
    v_mov_b32 v22, 0
    v_mov_b32 v23, 0
    v_mov_b32 v24, 0
    v_mov_b32 v25, 0
    v_mov_b32 v26, 0
    v_mov_b32 v27, 0
    v_mov_b32 v28, 0
    v_mov_b32 v29, 0
    v_mov_b32 v30, 0
    v_mov_b32 v31, 0
    v_mov_b32 v32, 0
    v_mov_b32 v33, 0
    v_mov_b32 v34, 0
    v_mov_b32 v35, 0
    v_mov_b32 v36, 0
    v_mov_b32 v37, 0
    v_mov_b32 v38, 0
    v_mov_b32 v39, 0
    v_mov_b32 v40, 0
    v_mov_b32 v41, 0
    v_mov_b32 v42, 0
    v_mov_b32 v43, 0
    v_mov_b32 v44, 0
    v_mov_b32 v45, 0
    v_mov_b32 v46, 0
    v_mov_b32 v47, 0
    v_mov_b32 v48, 0
    v_mov_b32 v49, 0
    v_mov_b32 v50, 0
    v_mov_b32 v51, 0
    v_mov_b32 v52, 0
    v_mov_b32 v53, 0
    v_mov_b32 v54, 0
    v_mov_b32 v55, 0
    v_mov_b32 v56, 0
    v_mov_b32 v57, 0
    v_mov_b32 v58, 0
    v_mov_b32 v59, 0
    v_mov_b32 v60, 0
    v_mov_b32 v61, 0
    v_mov_b32 v62, 0
    v_mov_b32 v63, 0
    v_mov_b32 v64, 0
    v_mov_b32 v65, 0
    v_mov_b32 v66, 0
    v_mov_b32 v67, 0
    v_mov_b32 v68, 0
    v_mov_b32 v69, 0
    v_mov_b32 v70, 0
    v_mov_b32 v71, 0
    v_mov_b32 v72, 0
    v_mov_b32 v73, 0
    v_mov_b32 v74, 0
    v_mov_b32 v75, 0
    v_mov_b32 v76, 0
    v_mov_b32 v77, 0
    v_mov_b32 v78, 0
    v_mov_b32 v79, 0
    v_mov_b32 v80, 0
    v_mov_b32 v81, 0
    v_mov_b32 v82, 0
    v_mov_b32 v83, 0
    v_mov_b32 v84, 0
    v_mov_b32 v85, 0
    v_mov_b32 v86, 0
    v_mov_b32 v87, 0
    v_mov_b32 v88, 0
    v_mov_b32 v89, 0
    v_mov_b32 v90, 0
    v_mov_b32 v91, 0
    v_mov_b32 v92, 0
    v_mov_b32 v93, 0
    v_mov_b32 v94, 0
    v_mov_b32 v95, 0
    v_mov_b32 v96, 0
    v_mov_b32 v97, 0
    v_mov_b32 v98, 0
    v_mov_b32 v99, 0
    v_mov_b32 v100, 0
    v_mov_b32 v101, 0
    v_mov_b32 v102, 0
    v_mov_b32 v103, 0
    v_mov_b32 v104, 0
    v_mov_b32 v105, 0
    v_mov_b32 v106, 0
    v_mov_b32 v107, 0
    v_mov_b32 v108, 0
    v_mov_b32 v109, 0
    v_mov_b32 v110, 0
    v_mov_b32 v111, 0
    v_mov_b32 v112, 0
    v_mov_b32 v113, 0
    v_mov_b32 v114, 0
    v_mov_b32 v115, 0
    v_mov_b32 v116, 0
    v_mov_b32 v117, 0
    v_mov_b32 v118, 0
    v_mov_b32 v119, 0
    v_mov_b32 v120, 0
    v_mov_b32 v121, 0
    v_mov_b32 v122, 0
    v_mov_b32 v123, 0
    v_mov_b32 v124, 0
    v_mov_b32 v125, 0
    v_mov_b32 v126, 0
    v_mov_b32 v127, 0
    v_mov_b32 v128, 0
    v_mov_b32 v129, 0
    v_mov_b32 v130, 0
    v_mov_b32 v131, 0
    v_mov_b32 v132, 0
    v_mov_b32 v133, 0
    v_mov_b32 v134, 0
    v_mov_b32 v135, 0
    v_mov_b32 v136, 0
    v_mov_b32 v137, 0
    v_mov_b32 v138, 0
    v_mov_b32 v139, 0
    v_mov_b32 v140, 0
    v_mov_b32 v141, 0
    v_mov_b32 v142, 0
    v_mov_b32 v143, 0
    v_mov_b32 v144, 0
    v_mov_b32 v145, 0
    v_mov_b32 v146, 0
    v_mov_b32 v147, 0
    v_mov_b32 v148, 0
    v_mov_b32 v149, 0
    v_mov_b32 v150, 0
    v_mov_b32 v151, 0
    v_mov_b32 v152, 0
    v_mov_b32 v153, 0
    v_mov_b32 v154, 0
    v_mov_b32 v155, 0
    v_mov_b32 v156, 0
    v_mov_b32 v157, 0
    v_mov_b32 v158, 0
    v_mov_b32 v159, 0
    v_mov_b32 v160, 0
    v_mov_b32 v161, 0
    v_mov_b32 v162, 0
    v_mov_b32 v163, 0
    v_mov_b32 v164, 0
    v_mov_b32 v165, 0
    v_mov_b32 v166, 0
    v_mov_b32 v167, 0
    v_lshlrev_b32 v4, 2, v3
    v_sub_u32 v4, v2, v4
    v_mov_b32 v5, 0xf149f2ca
    v_subrev_u32 v15, 0, v4
    v_and_b32 v15, 0x80000001, v15
    v_cmp_eq_u32 vcc, 0, v15
    s_nop 1
    v_cndmask_b32_e64 v228, v5, 0, vcc
    v_cndmask_b32_e64 v244, 0, -1, vcc
    v_cmp_eq_u32 vcc, 0x80000000, v15
    s_nop 1
    v_cndmask_b32_e64 v224, v5, 0, vcc
    v_cndmask_b32_e64 v240, 0, -1, vcc
    v_subrev_u32 v15, 1, v4
    v_and_b32 v15, 0x80000001, v15
    v_cmp_eq_u32 vcc, 0, v15
    s_nop 1
    v_cndmask_b32_e64 v229, v5, 0, vcc
    v_cndmask_b32_e64 v245, 0, -1, vcc
    v_cmp_eq_u32 vcc, 0x80000000, v15
    s_nop 1
    v_cndmask_b32_e64 v225, v5, 0, vcc
    v_cndmask_b32_e64 v241, 0, -1, vcc
    v_subrev_u32 v15, 2, v4
    v_and_b32 v15, 0x80000001, v15
    v_cmp_eq_u32 vcc, 0, v15
    s_nop 1
    v_cndmask_b32_e64 v230, v5, 0, vcc
    v_cndmask_b32_e64 v246, 0, -1, vcc
    v_cmp_eq_u32 vcc, 0x80000000, v15
    s_nop 1
    v_cndmask_b32_e64 v226, v5, 0, vcc
    v_cndmask_b32_e64 v242, 0, -1, vcc
    v_subrev_u32 v15, 3, v4
    v_and_b32 v15, 0x80000001, v15
    v_cmp_eq_u32 vcc, 0, v15
    s_nop 1
    v_cndmask_b32_e64 v231, v5, 0, vcc
    v_cndmask_b32_e64 v247, 0, -1, vcc
    v_cmp_eq_u32 vcc, 0x80000000, v15
    s_nop 1
    v_cndmask_b32_e64 v227, v5, 0, vcc
    v_cndmask_b32_e64 v243, 0, -1, vcc
    s_mov_b32 s30, 0xffff
    s_mov_b32 s22, 0x0c0c0c0c
    s_mov_b32 s26, 0x01000100
    s_mov_b32 s27, 0x03020302
    v_bfi_b32 v236, s30, v240, v241
    v_mov_b32 v15, s22
    v_bfi_b32 v236, v236, s26, v15
    v_bfi_b32 v237, s30, v242, v243
    v_mov_b32 v15, s22
    v_bfi_b32 v237, v237, s27, v15
    v_bfi_b32 v238, s30, v244, v245
    v_mov_b32 v15, s22
    v_bfi_b32 v238, v238, s26, v15
    v_bfi_b32 v239, s30, v246, v247
    v_mov_b32 v15, s22
    v_bfi_b32 v239, v239, s27, v15
    s_or_b32 s23, s16, s28
    s_cmp_eq_u32 s23, 0
    s_cselect_b64 vcc, -1, 0
    v_cndmask_b32 v232, v224, v5, vcc
    v_cndmask_b32 v233, v225, v5, vcc
    v_cndmask_b32 v234, v226, v5, vcc
    v_cndmask_b32 v235, v227, v5, vcc
    v_cmp_eq_u32 s[90:91], 0, v3
    v_cmp_eq_u32 s[92:93], 1, v3
    v_and_b32 v4, 1, v3
    v_cmp_eq_u32 s[94:95], 1, v4
    s_cmp_eq_u32 s29, 0
    s_cselect_b32 s96, -1, 0
    s_cselect_b32 s97, 0, -1
    s_lshl_b32 s23, s16, 3
    s_lshl_b32 s26, s28, 2
    s_add_u32 s23, s23, s26
    s_mul_i32 s23, s23, 40
    s_mul_i32 s26, s17, 5
    s_add_u32 s23, s23, s26
    s_lshl_b32 s23, s23, 9
    v_lshl_add_u32 v15, v1, 3, s23
    s_lshl_b32 s26, s29, 10
    v_add_u32 v12, s26, v15
    s_lshl_b32 s23, s16, 4
    s_add_u32 s23, s23, s17
    s_lshl_b32 s23, s23, 7
    s_add_u32 s23, s23, 131072
    v_lshl_add_u32 v14, v1, 10, s23
    s_mov_b32 s31, 0x3ea52b5c
    v_mov_b32 v6, s31
    s_mov_b32 s33, 0
    s_mov_b32 s37, 0
    s_waitcnt lgkmcnt(0)
    s_add_u32 s4, s20, 2621440
    s_addc_u32 s5, s21, 0
    s_mov_b32 s6, 2621440
    s_mov_b32 s7, 0x20000
    s_waitcnt lgkmcnt(0)
    s_mul_i32 s48, s48, 1664525
    s_add_u32 s48, s48, 1013904223
    s_barrier
    s_cmp_lg_u32 s28, 0
    s_cbranch_scc1 Lqa_h1
Lqa_h0:
    ds_read_b128 v[172:175], v8 offset:2048
    ds_read_b128 v[176:179], v8 offset:4096
    ds_read_b128 v[180:183], v8 offset:6144
    ds_read_b128 v[184:187], v8 offset:8192
    ds_read_b128 v[168:171], v8 offset:0
    ds_read_b64_tr_b16 v[208:209], v10 offset:0
    ds_read_b64_tr_b16 v[210:211], v10 offset:7680
    ds_read_b64_tr_b16 v[212:213], v10 offset:40
    ds_read_b64_tr_b16 v[214:215], v10 offset:7720
    ds_read_b64_tr_b16 v[216:217], v10 offset:160
    ds_read_b64_tr_b16 v[218:219], v10 offset:7840
    s_waitcnt lgkmcnt(4)
.p2align 3
Lqa_c0:
    v_mfma_f32_16x16x32_bf16 v[16:19], v[208:211], v[172:175], v[16:19]
    ds_read_b64_tr_b16 v[220:221], v10 offset:200
    v_mfma_f32_16x16x32_bf16 v[24:27], v[208:211], v[176:179], v[24:27]
    ds_read_b64_tr_b16 v[222:223], v10 offset:7880
    v_mfma_f32_16x16x32_bf16 v[32:35], v[208:211], v[180:183], v[32:35]
    v_mfma_f32_16x16x32_bf16 v[40:43], v[208:211], v[184:187], v[40:43]
    s_waitcnt lgkmcnt(4)
    v_mfma_f32_16x16x32_bf16 v[20:23], v[212:215], v[172:175], v[20:23]
    ds_read_b64_tr_b16 v[208:209], v11 offset:0
    v_mfma_f32_16x16x32_bf16 v[28:31], v[212:215], v[176:179], v[28:31]
    ds_read_b64_tr_b16 v[210:211], v11 offset:7680
    v_mfma_f32_16x16x32_bf16 v[36:39], v[212:215], v[180:183], v[36:39]
    ds_read_b128 v[192:195], v9 offset:2048
    v_mfma_f32_16x16x32_bf16 v[44:47], v[212:215], v[184:187], v[44:47]
    s_waitcnt lgkmcnt(5)
    v_mfma_f32_16x16x32_bf16 v[56:59], v[216:219], v[172:175], v[56:59]
    ds_read_b64_tr_b16 v[212:213], v10 offset:320
    v_mfma_f32_16x16x32_bf16 v[64:67], v[216:219], v[176:179], v[64:67]
    ds_read_b64_tr_b16 v[214:215], v10 offset:8000
    v_mfma_f32_16x16x32_bf16 v[72:75], v[216:219], v[180:183], v[72:75]
    ds_read_b128 v[196:199], v9 offset:4096
    v_mfma_f32_16x16x32_bf16 v[80:83], v[216:219], v[184:187], v[80:83]
    s_add_u32 s40, s37, 49152
    v_mfma_f32_16x16x32_bf16 v[48:51], v[216:219], v[168:171], v[48:51]
    s_waitcnt lgkmcnt(6)
    v_mfma_f32_16x16x32_bf16 v[60:63], v[220:223], v[172:175], v[60:63]
    ds_read_b64_tr_b16 v[216:217], v10 offset:360
    v_mfma_f32_16x16x32_bf16 v[68:71], v[220:223], v[176:179], v[68:71]
    ds_read_b64_tr_b16 v[218:219], v10 offset:8040
    v_mfma_f32_16x16x32_bf16 v[76:79], v[220:223], v[180:183], v[76:79]
    ds_read_b128 v[200:203], v9 offset:6144
    v_mfma_f32_16x16x32_bf16 v[84:87], v[220:223], v[184:187], v[84:87]
    s_cmp_ge_u32 s40, 147456
    v_mfma_f32_16x16x32_bf16 v[52:55], v[220:223], v[168:171], v[52:55]
    s_waitcnt lgkmcnt(7)
    v_mfma_f32_16x16x32_bf16 v[92:95], v[208:211], v[172:175], v[92:95]
    ds_read_b64_tr_b16 v[220:221], v13 offset:320
    v_mfma_f32_16x16x32_bf16 v[96:99], v[208:211], v[176:179], v[96:99]
    ds_read_b64_tr_b16 v[222:223], v13 offset:8000
    v_mfma_f32_16x16x32_bf16 v[100:103], v[208:211], v[180:183], v[100:103]
    ds_read_b128 v[204:207], v9 offset:8192
    v_mfma_f32_16x16x32_bf16 v[104:107], v[208:211], v[184:187], v[104:107]
    s_cselect_b32 s41, 0, s40
    v_mfma_f32_16x16x32_bf16 v[88:91], v[208:211], v[168:171], v[88:91]
    s_waitcnt lgkmcnt(7)
    v_mfma_f32_16x16x32_bf16 v[112:115], v[172:175], v[212:215], v[112:115]
    ds_read_b64_tr_b16 v[208:209], v10 offset:15360
    v_mfma_f32_16x16x32_bf16 v[116:119], v[176:179], v[212:215], v[116:119]
    ds_read_b64_tr_b16 v[210:211], v10 offset:23040
    v_mfma_f32_16x16x32_bf16 v[120:123], v[180:183], v[212:215], v[120:123]
    ds_read_b128 v[188:191], v9 offset:0
    s_sub_u32 s40, s41, s37
    v_mfma_f32_16x16x32_bf16 v[124:127], v[184:187], v[212:215], v[124:127]
    s_waitcnt lgkmcnt(7)
    v_mfma_f32_16x16x32_bf16 v[132:135], v[172:175], v[216:219], v[132:135]
    ds_read_b64_tr_b16 v[212:213], v10 offset:15400
    v_mfma_f32_16x16x32_bf16 v[136:139], v[176:179], v[216:219], v[136:139]
    ds_read_b64_tr_b16 v[214:215], v10 offset:23080
    v_mfma_f32_16x16x32_bf16 v[140:143], v[180:183], v[216:219], v[140:143]
    s_mov_b32 s37, s41
    v_mfma_f32_16x16x32_bf16 v[144:147], v[184:187], v[216:219], v[144:147]
    s_waitcnt lgkmcnt(6)
    v_mfma_f32_16x16x32_bf16 v[152:155], v[172:175], v[220:223], v[152:155]
    ds_read_b64_tr_b16 v[216:217], v10 offset:15520
    v_mfma_f32_16x16x32_bf16 v[156:159], v[176:179], v[220:223], v[156:159]
    ds_read_b64_tr_b16 v[218:219], v10 offset:23200
    v_mfma_f32_16x16x32_bf16 v[160:163], v[180:183], v[220:223], v[160:163]
    s_add_u32 s33, s33, 1
    v_mfma_f32_16x16x32_bf16 v[164:167], v[184:187], v[220:223], v[164:167]
    s_waitcnt lgkmcnt(4)
    v_mfma_f32_16x16x32_bf16 v[16:19], v[208:211], v[192:195], v[16:19]
    ds_read_b64_tr_b16 v[220:221], v10 offset:15560
    v_mfma_f32_16x16x32_bf16 v[24:27], v[208:211], v[196:199], v[24:27]
    ds_read_b64_tr_b16 v[222:223], v10 offset:23240
    v_mfma_f32_16x16x32_bf16 v[32:35], v[208:211], v[200:203], v[32:35]
    s_cmp_ge_u32 s33, 10
    v_mfma_f32_16x16x32_bf16 v[40:43], v[208:211], v[204:207], v[40:43]
    s_waitcnt lgkmcnt(4)
    v_mfma_f32_16x16x32_bf16 v[20:23], v[212:215], v[192:195], v[20:23]
    ds_read_b64_tr_b16 v[208:209], v11 offset:15360
    v_mfma_f32_16x16x32_bf16 v[28:31], v[212:215], v[196:199], v[28:31]
    ds_read_b64_tr_b16 v[210:211], v11 offset:23040
    v_mfma_f32_16x16x32_bf16 v[36:39], v[212:215], v[200:203], v[36:39]
    v_mfma_f32_16x16x32_bf16 v[44:47], v[212:215], v[204:207], v[44:47]
    s_waitcnt lgkmcnt(4)
    v_mfma_f32_16x16x32_bf16 v[56:59], v[216:219], v[192:195], v[56:59]
    ds_read_b64_tr_b16 v[212:213], v10 offset:15680
    v_mfma_f32_16x16x32_bf16 v[64:67], v[216:219], v[196:199], v[64:67]
    ds_read_b64_tr_b16 v[214:215], v10 offset:23360
    v_mfma_f32_16x16x32_bf16 v[72:75], v[216:219], v[200:203], v[72:75]
    v_mfma_f32_16x16x32_bf16 v[80:83], v[216:219], v[204:207], v[80:83]
    v_mfma_f32_16x16x32_bf16 v[48:51], v[216:219], v[188:191], v[48:51]
    s_waitcnt lgkmcnt(4)
    v_mfma_f32_16x16x32_bf16 v[60:63], v[220:223], v[192:195], v[60:63]
    ds_read_b64_tr_b16 v[216:217], v10 offset:15720
    v_mfma_f32_16x16x32_bf16 v[68:71], v[220:223], v[196:199], v[68:71]
    ds_read_b64_tr_b16 v[218:219], v10 offset:23400
    v_mfma_f32_16x16x32_bf16 v[76:79], v[220:223], v[200:203], v[76:79]
    v_mfma_f32_16x16x32_bf16 v[84:87], v[220:223], v[204:207], v[84:87]
    v_mfma_f32_16x16x32_bf16 v[52:55], v[220:223], v[188:191], v[52:55]
    s_waitcnt lgkmcnt(4)
    v_mfma_f32_16x16x32_bf16 v[92:95], v[208:211], v[192:195], v[92:95]
    ds_read_b64_tr_b16 v[220:221], v13 offset:15680
    v_mfma_f32_16x16x32_bf16 v[96:99], v[208:211], v[196:199], v[96:99]
    ds_read_b64_tr_b16 v[222:223], v13 offset:23360
    v_mfma_f32_16x16x32_bf16 v[100:103], v[208:211], v[200:203], v[100:103]
    v_add_u32 v8, s40, v8
    v_add_u32 v9, s40, v9
    v_add_u32 v10, s40, v10
    v_mfma_f32_16x16x32_bf16 v[104:107], v[208:211], v[204:207], v[104:107]
    v_add_u32 v11, s40, v11
    v_add_u32 v13, s40, v13
    v_mfma_f32_16x16x32_bf16 v[88:91], v[208:211], v[188:191], v[88:91]
    s_waitcnt lgkmcnt(0)
    s_cbranch_scc1 Lqa_clast0
    s_barrier
    v_mfma_f32_16x16x32_bf16 v[112:115], v[192:195], v[212:215], v[112:115]
    ds_read_b128 v[172:175], v8 offset:2048
    ds_read_b128 v[176:179], v8 offset:4096
    v_mfma_f32_16x16x32_bf16 v[116:119], v[196:199], v[212:215], v[116:119]
    ds_read_b128 v[180:183], v8 offset:6144
    ds_read_b128 v[184:187], v8 offset:8192
    v_mfma_f32_16x16x32_bf16 v[120:123], v[200:203], v[212:215], v[120:123]
    ds_read_b128 v[168:171], v8 offset:0
    ds_read_b64_tr_b16 v[208:209], v10 offset:0
    v_mfma_f32_16x16x32_bf16 v[124:127], v[204:207], v[212:215], v[124:127]
    ds_read_b64_tr_b16 v[210:211], v10 offset:7680
    v_mfma_f32_16x16x32_bf16 v[132:135], v[192:195], v[216:219], v[132:135]
    ds_read_b64_tr_b16 v[212:213], v10 offset:40
    v_mfma_f32_16x16x32_bf16 v[136:139], v[196:199], v[216:219], v[136:139]
    ds_read_b64_tr_b16 v[214:215], v10 offset:7720
    v_mfma_f32_16x16x32_bf16 v[140:143], v[200:203], v[216:219], v[140:143]
    v_mfma_f32_16x16x32_bf16 v[144:147], v[204:207], v[216:219], v[144:147]
    v_mfma_f32_16x16x32_bf16 v[152:155], v[192:195], v[220:223], v[152:155]
    ds_read_b64_tr_b16 v[216:217], v10 offset:160
    v_mfma_f32_16x16x32_bf16 v[156:159], v[196:199], v[220:223], v[156:159]
    ds_read_b64_tr_b16 v[218:219], v10 offset:7840
    v_mfma_f32_16x16x32_bf16 v[160:163], v[200:203], v[220:223], v[160:163]
    v_mfma_f32_16x16x32_bf16 v[164:167], v[204:207], v[220:223], v[164:167]
    s_waitcnt lgkmcnt(4)
    s_branch Lqa_c0
Lqa_clast0:
    v_mfma_f32_16x16x32_bf16 v[112:115], v[192:195], v[212:215], v[112:115]
    v_cvt_pk_bf16_f32 v80, v80, v81
    v_cvt_pk_bf16_f32 v81, v82, v83
    v_mfma_f32_16x16x32_bf16 v[116:119], v[196:199], v[212:215], v[116:119]
    v_cvt_pk_bf16_f32 v84, v84, v85
    v_cvt_pk_bf16_f32 v85, v86, v87
    v_mfma_f32_16x16x32_bf16 v[120:123], v[200:203], v[212:215], v[120:123]
    v_cvt_pk_bf16_f32 v82, v104, v105
    v_cvt_pk_bf16_f32 v83, v106, v107
    v_mfma_f32_16x16x32_bf16 v[124:127], v[204:207], v[212:215], v[124:127]
    v_cvt_pk_bf16_f32 v104, v104, v105
    v_cvt_pk_bf16_f32 v105, v106, v107
    v_mfma_f32_16x16x32_bf16 v[132:135], v[192:195], v[216:219], v[132:135]
    v_cvt_pk_bf16_f32 v72, v72, v73
    v_cvt_pk_bf16_f32 v73, v74, v75
    v_mfma_f32_16x16x32_bf16 v[136:139], v[196:199], v[216:219], v[136:139]
    v_cvt_pk_bf16_f32 v76, v76, v77
    v_cvt_pk_bf16_f32 v77, v78, v79
    v_mfma_f32_16x16x32_bf16 v[140:143], v[200:203], v[216:219], v[140:143]
    v_cvt_pk_bf16_f32 v74, v100, v101
    v_cvt_pk_bf16_f32 v75, v102, v103
    v_mfma_f32_16x16x32_bf16 v[144:147], v[204:207], v[216:219], v[144:147]
    v_cvt_pk_bf16_f32 v100, v100, v101
    v_cvt_pk_bf16_f32 v101, v102, v103
    v_mfma_f32_16x16x32_bf16 v[152:155], v[192:195], v[220:223], v[152:155]
    v_cvt_pk_bf16_f32 v64, v64, v65
    v_cvt_pk_bf16_f32 v65, v66, v67
    v_mfma_f32_16x16x32_bf16 v[156:159], v[196:199], v[220:223], v[156:159]
    v_cvt_pk_bf16_f32 v68, v68, v69
    v_cvt_pk_bf16_f32 v69, v70, v71
    v_mfma_f32_16x16x32_bf16 v[160:163], v[200:203], v[220:223], v[160:163]
    v_cvt_pk_bf16_f32 v66, v96, v97
    v_cvt_pk_bf16_f32 v67, v98, v99
    v_mfma_f32_16x16x32_bf16 v[164:167], v[204:207], v[220:223], v[164:167]
    v_cvt_pk_bf16_f32 v96, v96, v97
    v_cvt_pk_bf16_f32 v97, v98, v99
    v_lshlrev_b32 v8, 3, v1
    s_mul_i32 s23, s29, 20480
    s_add_u32 s23, s23, 61440
    v_add_u32 v8, s23, v8
    v_cvt_pk_bf16_f32 v56, v56, v57
    v_cvt_pk_bf16_f32 v57, v58, v59
    v_cvt_pk_bf16_f32 v60, v60, v61
    v_cvt_pk_bf16_f32 v61, v62, v63
    v_cvt_pk_bf16_f32 v58, v92, v93
    v_cvt_pk_bf16_f32 v59, v94, v95
    v_cvt_pk_bf16_f32 v92, v92, v93
    v_cvt_pk_bf16_f32 v93, v94, v95
    v_cvt_pk_bf16_f32 v48, v48, v49
    v_cvt_pk_bf16_f32 v49, v50, v51
    v_cvt_pk_bf16_f32 v52, v52, v53
    v_cvt_pk_bf16_f32 v53, v54, v55
    v_cvt_pk_bf16_f32 v50, v88, v89
    v_cvt_pk_bf16_f32 v51, v90, v91
    v_cvt_pk_bf16_f32 v88, v88, v89
    v_cvt_pk_bf16_f32 v89, v90, v91
    v_permlane32_swap_b32 v104, v82
    v_permlane32_swap_b32 v105, v83
    v_permlane32_swap_b32 v100, v74
    v_permlane32_swap_b32 v101, v75
    v_permlane32_swap_b32 v96, v66
    v_permlane32_swap_b32 v97, v67
    v_permlane32_swap_b32 v92, v58
    v_permlane32_swap_b32 v93, v59
    v_permlane32_swap_b32 v88, v50
    v_permlane32_swap_b32 v89, v51
    ds_write_b64 v8, v[80:81] offset:0
    ds_write_b64 v8, v[82:83] offset:512
    ds_write_b64 v8, v[84:85] offset:1024
    v_cvt_pk_bf16_f32 v110, v112, v113
    v_cvt_pk_bf16_f32 v111, v114, v115
    v_cvt_pk_bf16_f32 v112, v116, v117
    v_cvt_pk_bf16_f32 v113, v118, v119
    v_cvt_pk_bf16_f32 v114, v120, v121
    v_cvt_pk_bf16_f32 v115, v122, v123
    v_cvt_pk_bf16_f32 v116, v124, v125
    v_cvt_pk_bf16_f32 v117, v126, v127
    ds_write_b64 v8, v[116:117] offset:1536
    v_cvt_pk_bf16_f32 v130, v132, v133
    v_cvt_pk_bf16_f32 v131, v134, v135
    v_cvt_pk_bf16_f32 v132, v136, v137
    v_cvt_pk_bf16_f32 v133, v138, v139
    v_cvt_pk_bf16_f32 v134, v140, v141
    v_cvt_pk_bf16_f32 v135, v142, v143
    v_cvt_pk_bf16_f32 v136, v144, v145
    v_cvt_pk_bf16_f32 v137, v146, v147
    ds_write_b64 v8, v[136:137] offset:2048
    v_cvt_pk_bf16_f32 v150, v152, v153
    v_cvt_pk_bf16_f32 v151, v154, v155
    v_cvt_pk_bf16_f32 v152, v156, v157
    v_cvt_pk_bf16_f32 v153, v158, v159
    v_cvt_pk_bf16_f32 v154, v160, v161
    v_cvt_pk_bf16_f32 v155, v162, v163
    v_cvt_pk_bf16_f32 v156, v164, v165
    v_cvt_pk_bf16_f32 v157, v166, v167
    ds_write_b64 v8, v[156:157] offset:2560
    s_waitcnt lgkmcnt(0)
    s_barrier
    ds_read_b64 v[108:109], v8 offset:3072
    ds_read_b64 v[128:129], v8 offset:3584
    ds_read_b64 v[148:149], v8 offset:4096
    s_branch Lqa_j
Lqa_h1:
    ds_read_b128 v[172:175], v8 offset:10240
    ds_read_b128 v[176:179], v8 offset:12288
    ds_read_b128 v[180:183], v8 offset:14336
    ds_read_b128 v[184:187], v8 offset:16384
    ds_read_b128 v[168:171], v8 offset:0
    ds_read_b64_tr_b16 v[208:209], v10 offset:0
    ds_read_b64_tr_b16 v[210:211], v10 offset:7680
    ds_read_b64_tr_b16 v[212:213], v10 offset:40
    ds_read_b64_tr_b16 v[214:215], v10 offset:7720
    ds_read_b64_tr_b16 v[216:217], v10 offset:160
    ds_read_b64_tr_b16 v[218:219], v10 offset:7840
    s_waitcnt lgkmcnt(4)
.p2align 3
Lqa_c1:
    v_mfma_f32_16x16x32_bf16 v[16:19], v[208:211], v[172:175], v[16:19]
    ds_read_b64_tr_b16 v[220:221], v10 offset:200
    v_mfma_f32_16x16x32_bf16 v[24:27], v[208:211], v[176:179], v[24:27]
    ds_read_b64_tr_b16 v[222:223], v10 offset:7880
    v_mfma_f32_16x16x32_bf16 v[32:35], v[208:211], v[180:183], v[32:35]
    v_mfma_f32_16x16x32_bf16 v[40:43], v[208:211], v[184:187], v[40:43]
    s_waitcnt lgkmcnt(4)
    v_mfma_f32_16x16x32_bf16 v[20:23], v[212:215], v[172:175], v[20:23]
    ds_read_b64_tr_b16 v[208:209], v11 offset:0
    v_mfma_f32_16x16x32_bf16 v[28:31], v[212:215], v[176:179], v[28:31]
    ds_read_b64_tr_b16 v[210:211], v11 offset:7680
    v_mfma_f32_16x16x32_bf16 v[36:39], v[212:215], v[180:183], v[36:39]
    ds_read_b128 v[192:195], v9 offset:10240
    v_mfma_f32_16x16x32_bf16 v[44:47], v[212:215], v[184:187], v[44:47]
    s_waitcnt lgkmcnt(5)
    v_mfma_f32_16x16x32_bf16 v[56:59], v[216:219], v[172:175], v[56:59]
    ds_read_b64_tr_b16 v[212:213], v10 offset:320
    v_mfma_f32_16x16x32_bf16 v[64:67], v[216:219], v[176:179], v[64:67]
    ds_read_b64_tr_b16 v[214:215], v10 offset:8000
    v_mfma_f32_16x16x32_bf16 v[72:75], v[216:219], v[180:183], v[72:75]
    ds_read_b128 v[196:199], v9 offset:12288
    s_add_u32 s40, s37, 49152
    v_mfma_f32_16x16x32_bf16 v[80:83], v[216:219], v[184:187], v[80:83]
    s_waitcnt lgkmcnt(6)
    v_mfma_f32_16x16x32_bf16 v[60:63], v[220:223], v[172:175], v[60:63]
    ds_read_b64_tr_b16 v[216:217], v10 offset:360
    v_mfma_f32_16x16x32_bf16 v[68:71], v[220:223], v[176:179], v[68:71]
    ds_read_b64_tr_b16 v[218:219], v10 offset:8040
    v_mfma_f32_16x16x32_bf16 v[76:79], v[220:223], v[180:183], v[76:79]
    ds_read_b128 v[200:203], v9 offset:14336
    s_cmp_ge_u32 s40, 147456
    v_mfma_f32_16x16x32_bf16 v[84:87], v[220:223], v[184:187], v[84:87]
    s_waitcnt lgkmcnt(7)
    v_mfma_f32_16x16x32_bf16 v[92:95], v[208:211], v[172:175], v[92:95]
    ds_read_b64_tr_b16 v[220:221], v13 offset:320
    v_mfma_f32_16x16x32_bf16 v[96:99], v[208:211], v[176:179], v[96:99]
    ds_read_b64_tr_b16 v[222:223], v13 offset:8000
    v_mfma_f32_16x16x32_bf16 v[100:103], v[208:211], v[180:183], v[100:103]
    ds_read_b128 v[204:207], v9 offset:16384
    s_cselect_b32 s41, 0, s40
    v_mfma_f32_16x16x32_bf16 v[104:107], v[208:211], v[184:187], v[104:107]
    s_waitcnt lgkmcnt(7)
    v_mfma_f32_16x16x32_bf16 v[112:115], v[172:175], v[212:215], v[112:115]
    ds_read_b64_tr_b16 v[208:209], v10 offset:15360
    v_mfma_f32_16x16x32_bf16 v[116:119], v[176:179], v[212:215], v[116:119]
    ds_read_b64_tr_b16 v[210:211], v10 offset:23040
    v_mfma_f32_16x16x32_bf16 v[120:123], v[180:183], v[212:215], v[120:123]
    ds_read_b128 v[188:191], v9 offset:0
    v_mfma_f32_16x16x32_bf16 v[124:127], v[184:187], v[212:215], v[124:127]
    s_sub_u32 s40, s41, s37
    v_mfma_f32_16x16x32_bf16 v[108:111], v[168:171], v[212:215], v[108:111]
    s_waitcnt lgkmcnt(7)
    v_mfma_f32_16x16x32_bf16 v[132:135], v[172:175], v[216:219], v[132:135]
    ds_read_b64_tr_b16 v[212:213], v10 offset:15400
    v_mfma_f32_16x16x32_bf16 v[136:139], v[176:179], v[216:219], v[136:139]
    ds_read_b64_tr_b16 v[214:215], v10 offset:23080
    v_mfma_f32_16x16x32_bf16 v[140:143], v[180:183], v[216:219], v[140:143]
    v_mfma_f32_16x16x32_bf16 v[144:147], v[184:187], v[216:219], v[144:147]
    s_mov_b32 s37, s41
    v_mfma_f32_16x16x32_bf16 v[128:131], v[168:171], v[216:219], v[128:131]
    s_waitcnt lgkmcnt(6)
    v_mfma_f32_16x16x32_bf16 v[152:155], v[172:175], v[220:223], v[152:155]
    ds_read_b64_tr_b16 v[216:217], v10 offset:15520
    v_mfma_f32_16x16x32_bf16 v[156:159], v[176:179], v[220:223], v[156:159]
    ds_read_b64_tr_b16 v[218:219], v10 offset:23200
    v_mfma_f32_16x16x32_bf16 v[160:163], v[180:183], v[220:223], v[160:163]
    v_mfma_f32_16x16x32_bf16 v[164:167], v[184:187], v[220:223], v[164:167]
    s_add_u32 s33, s33, 1
    v_mfma_f32_16x16x32_bf16 v[148:151], v[168:171], v[220:223], v[148:151]
    s_waitcnt lgkmcnt(4)
    v_mfma_f32_16x16x32_bf16 v[16:19], v[208:211], v[192:195], v[16:19]
    ds_read_b64_tr_b16 v[220:221], v10 offset:15560
    v_mfma_f32_16x16x32_bf16 v[24:27], v[208:211], v[196:199], v[24:27]
    ds_read_b64_tr_b16 v[222:223], v10 offset:23240
    v_mfma_f32_16x16x32_bf16 v[32:35], v[208:211], v[200:203], v[32:35]
    s_cmp_ge_u32 s33, 10
    v_mfma_f32_16x16x32_bf16 v[40:43], v[208:211], v[204:207], v[40:43]
    s_waitcnt lgkmcnt(4)
    v_mfma_f32_16x16x32_bf16 v[20:23], v[212:215], v[192:195], v[20:23]
    ds_read_b64_tr_b16 v[208:209], v11 offset:15360
    v_mfma_f32_16x16x32_bf16 v[28:31], v[212:215], v[196:199], v[28:31]
    ds_read_b64_tr_b16 v[210:211], v11 offset:23040
    v_mfma_f32_16x16x32_bf16 v[36:39], v[212:215], v[200:203], v[36:39]
    v_mfma_f32_16x16x32_bf16 v[44:47], v[212:215], v[204:207], v[44:47]
    s_waitcnt lgkmcnt(4)
    v_mfma_f32_16x16x32_bf16 v[56:59], v[216:219], v[192:195], v[56:59]
    ds_read_b64_tr_b16 v[212:213], v10 offset:15680
    v_mfma_f32_16x16x32_bf16 v[64:67], v[216:219], v[196:199], v[64:67]
    ds_read_b64_tr_b16 v[214:215], v10 offset:23360
    v_mfma_f32_16x16x32_bf16 v[72:75], v[216:219], v[200:203], v[72:75]
    v_mfma_f32_16x16x32_bf16 v[80:83], v[216:219], v[204:207], v[80:83]
    s_waitcnt lgkmcnt(4)
    v_mfma_f32_16x16x32_bf16 v[60:63], v[220:223], v[192:195], v[60:63]
    ds_read_b64_tr_b16 v[216:217], v10 offset:15720
    v_mfma_f32_16x16x32_bf16 v[68:71], v[220:223], v[196:199], v[68:71]
    ds_read_b64_tr_b16 v[218:219], v10 offset:23400
    v_mfma_f32_16x16x32_bf16 v[76:79], v[220:223], v[200:203], v[76:79]
    v_mfma_f32_16x16x32_bf16 v[84:87], v[220:223], v[204:207], v[84:87]
    s_waitcnt lgkmcnt(4)
    v_mfma_f32_16x16x32_bf16 v[92:95], v[208:211], v[192:195], v[92:95]
    ds_read_b64_tr_b16 v[220:221], v13 offset:15680
    v_mfma_f32_16x16x32_bf16 v[96:99], v[208:211], v[196:199], v[96:99]
    ds_read_b64_tr_b16 v[222:223], v13 offset:23360
    v_mfma_f32_16x16x32_bf16 v[100:103], v[208:211], v[200:203], v[100:103]
    v_add_u32 v8, s40, v8
    v_add_u32 v9, s40, v9
    v_add_u32 v10, s40, v10
    v_mfma_f32_16x16x32_bf16 v[104:107], v[208:211], v[204:207], v[104:107]
    v_add_u32 v11, s40, v11
    v_add_u32 v13, s40, v13
    s_waitcnt lgkmcnt(0)
    s_cbranch_scc1 Lqa_clast1
    s_barrier
    v_mfma_f32_16x16x32_bf16 v[112:115], v[192:195], v[212:215], v[112:115]
    ds_read_b128 v[172:175], v8 offset:10240
    ds_read_b128 v[176:179], v8 offset:12288
    v_mfma_f32_16x16x32_bf16 v[116:119], v[196:199], v[212:215], v[116:119]
    ds_read_b128 v[180:183], v8 offset:14336
    ds_read_b128 v[184:187], v8 offset:16384
    v_mfma_f32_16x16x32_bf16 v[120:123], v[200:203], v[212:215], v[120:123]
    ds_read_b128 v[168:171], v8 offset:0
    ds_read_b64_tr_b16 v[208:209], v10 offset:0
    v_mfma_f32_16x16x32_bf16 v[124:127], v[204:207], v[212:215], v[124:127]
    ds_read_b64_tr_b16 v[210:211], v10 offset:7680
    v_mfma_f32_16x16x32_bf16 v[108:111], v[188:191], v[212:215], v[108:111]
    v_mfma_f32_16x16x32_bf16 v[132:135], v[192:195], v[216:219], v[132:135]
    ds_read_b64_tr_b16 v[212:213], v10 offset:40
    v_mfma_f32_16x16x32_bf16 v[136:139], v[196:199], v[216:219], v[136:139]
    ds_read_b64_tr_b16 v[214:215], v10 offset:7720
    v_mfma_f32_16x16x32_bf16 v[140:143], v[200:203], v[216:219], v[140:143]
    v_mfma_f32_16x16x32_bf16 v[144:147], v[204:207], v[216:219], v[144:147]
    v_mfma_f32_16x16x32_bf16 v[128:131], v[188:191], v[216:219], v[128:131]
    v_mfma_f32_16x16x32_bf16 v[152:155], v[192:195], v[220:223], v[152:155]
    ds_read_b64_tr_b16 v[216:217], v10 offset:160
    v_mfma_f32_16x16x32_bf16 v[156:159], v[196:199], v[220:223], v[156:159]
    ds_read_b64_tr_b16 v[218:219], v10 offset:7840
    v_mfma_f32_16x16x32_bf16 v[160:163], v[200:203], v[220:223], v[160:163]
    v_mfma_f32_16x16x32_bf16 v[164:167], v[204:207], v[220:223], v[164:167]
    v_mfma_f32_16x16x32_bf16 v[148:151], v[188:191], v[220:223], v[148:151]
    s_waitcnt lgkmcnt(4)
    s_branch Lqa_c1
Lqa_clast1:
    v_mfma_f32_16x16x32_bf16 v[112:115], v[192:195], v[212:215], v[112:115]
    v_cvt_pk_bf16_f32 v80, v80, v81
    v_cvt_pk_bf16_f32 v81, v82, v83
    v_mfma_f32_16x16x32_bf16 v[116:119], v[196:199], v[212:215], v[116:119]
    v_cvt_pk_bf16_f32 v84, v84, v85
    v_cvt_pk_bf16_f32 v85, v86, v87
    v_mfma_f32_16x16x32_bf16 v[120:123], v[200:203], v[212:215], v[120:123]
    v_cvt_pk_bf16_f32 v82, v104, v105
    v_cvt_pk_bf16_f32 v83, v106, v107
    v_mfma_f32_16x16x32_bf16 v[124:127], v[204:207], v[212:215], v[124:127]
    v_cvt_pk_bf16_f32 v104, v104, v105
    v_cvt_pk_bf16_f32 v105, v106, v107
    v_mfma_f32_16x16x32_bf16 v[108:111], v[188:191], v[212:215], v[108:111]
    v_cvt_pk_bf16_f32 v72, v72, v73
    v_cvt_pk_bf16_f32 v73, v74, v75
    v_mfma_f32_16x16x32_bf16 v[132:135], v[192:195], v[216:219], v[132:135]
    v_cvt_pk_bf16_f32 v76, v76, v77
    v_cvt_pk_bf16_f32 v77, v78, v79
    v_mfma_f32_16x16x32_bf16 v[136:139], v[196:199], v[216:219], v[136:139]
    v_cvt_pk_bf16_f32 v74, v100, v101
    v_cvt_pk_bf16_f32 v75, v102, v103
    v_mfma_f32_16x16x32_bf16 v[140:143], v[200:203], v[216:219], v[140:143]
    v_cvt_pk_bf16_f32 v100, v100, v101
    v_cvt_pk_bf16_f32 v101, v102, v103
    v_mfma_f32_16x16x32_bf16 v[144:147], v[204:207], v[216:219], v[144:147]
    v_cvt_pk_bf16_f32 v64, v64, v65
    v_cvt_pk_bf16_f32 v65, v66, v67
    v_mfma_f32_16x16x32_bf16 v[128:131], v[188:191], v[216:219], v[128:131]
    v_cvt_pk_bf16_f32 v68, v68, v69
    v_cvt_pk_bf16_f32 v69, v70, v71
    v_mfma_f32_16x16x32_bf16 v[152:155], v[192:195], v[220:223], v[152:155]
    v_cvt_pk_bf16_f32 v66, v96, v97
    v_cvt_pk_bf16_f32 v67, v98, v99
    v_mfma_f32_16x16x32_bf16 v[156:159], v[196:199], v[220:223], v[156:159]
    v_cvt_pk_bf16_f32 v96, v96, v97
    v_cvt_pk_bf16_f32 v97, v98, v99
    v_mfma_f32_16x16x32_bf16 v[160:163], v[200:203], v[220:223], v[160:163]
    v_cvt_pk_bf16_f32 v56, v56, v57
    v_cvt_pk_bf16_f32 v57, v58, v59
    v_mfma_f32_16x16x32_bf16 v[164:167], v[204:207], v[220:223], v[164:167]
    v_cvt_pk_bf16_f32 v60, v60, v61
    v_cvt_pk_bf16_f32 v61, v62, v63
    v_mfma_f32_16x16x32_bf16 v[148:151], v[188:191], v[220:223], v[148:151]
    v_cvt_pk_bf16_f32 v58, v92, v93
    v_cvt_pk_bf16_f32 v59, v94, v95
    v_lshlrev_b32 v8, 3, v1
    s_mul_i32 s23, s29, 20480
    s_add_u32 s23, s23, 61440
    v_add_u32 v8, s23, v8
    v_cvt_pk_bf16_f32 v92, v92, v93
    v_cvt_pk_bf16_f32 v93, v94, v95
    v_permlane32_swap_b32 v104, v82
    v_permlane32_swap_b32 v105, v83
    v_permlane32_swap_b32 v100, v74
    v_permlane32_swap_b32 v101, v75
    v_permlane32_swap_b32 v96, v66
    v_permlane32_swap_b32 v97, v67
    v_permlane32_swap_b32 v92, v58
    v_permlane32_swap_b32 v93, v59
    v_cvt_pk_bf16_f32 v108, v108, v109
    v_cvt_pk_bf16_f32 v109, v110, v111
    v_cvt_pk_bf16_f32 v110, v112, v113
    v_cvt_pk_bf16_f32 v111, v114, v115
    v_cvt_pk_bf16_f32 v112, v116, v117
    v_cvt_pk_bf16_f32 v113, v118, v119
    v_cvt_pk_bf16_f32 v114, v120, v121
    v_cvt_pk_bf16_f32 v115, v122, v123
    v_cvt_pk_bf16_f32 v116, v124, v125
    v_cvt_pk_bf16_f32 v117, v126, v127
    ds_write_b64 v8, v[108:109] offset:3072
    v_cvt_pk_bf16_f32 v128, v128, v129
    v_cvt_pk_bf16_f32 v129, v130, v131
    v_cvt_pk_bf16_f32 v130, v132, v133
    v_cvt_pk_bf16_f32 v131, v134, v135
    v_cvt_pk_bf16_f32 v132, v136, v137
    v_cvt_pk_bf16_f32 v133, v138, v139
    v_cvt_pk_bf16_f32 v134, v140, v141
    v_cvt_pk_bf16_f32 v135, v142, v143
    v_cvt_pk_bf16_f32 v136, v144, v145
    v_cvt_pk_bf16_f32 v137, v146, v147
    ds_write_b64 v8, v[128:129] offset:3584
    v_cvt_pk_bf16_f32 v148, v148, v149
    v_cvt_pk_bf16_f32 v149, v150, v151
    v_cvt_pk_bf16_f32 v150, v152, v153
    v_cvt_pk_bf16_f32 v151, v154, v155
    v_cvt_pk_bf16_f32 v152, v156, v157
    v_cvt_pk_bf16_f32 v153, v158, v159
    v_cvt_pk_bf16_f32 v154, v160, v161
    v_cvt_pk_bf16_f32 v155, v162, v163
    v_cvt_pk_bf16_f32 v156, v164, v165
    v_cvt_pk_bf16_f32 v157, v166, v167
    ds_write_b64 v8, v[148:149] offset:4096
    s_waitcnt lgkmcnt(0)
    s_barrier
    ds_read_b64 v[48:49], v8 offset:0
    ds_read_b64 v[50:51], v8 offset:512
    ds_read_b64 v[52:53], v8 offset:1024
    ds_read_b64 v[108:109], v8 offset:1536
    ds_read_b64 v[128:129], v8 offset:2048
    ds_read_b64 v[148:149], v8 offset:2560
Lqa_j:
    v_cvt_pk_bf16_f32 v40, v40, v41
    v_cvt_pk_bf16_f32 v41, v42, v43
    v_cvt_pk_bf16_f32 v47, v46, v47
    v_cvt_pk_bf16_f32 v46, v44, v45
    v_cndmask_b32 v42, 0, v104, s[90:91]
    v_cndmask_b32 v43, 0, v105, s[90:91]
    v_cndmask_b32 v44, 0, v104, s[92:93]
    v_cndmask_b32 v45, 0, v105, s[92:93]
    v_mfma_f32_16x16x32_bf16 v[168:171], v[72:75], v[40:43], v[224:227]
    v_cvt_pk_bf16_f32 v32, v32, v33
    v_cvt_pk_bf16_f32 v33, v34, v35
    v_mfma_f32_16x16x32_bf16 v[172:175], v[80:83], v[40:43], v[228:231]
    v_cvt_pk_bf16_f32 v39, v38, v39
    v_cvt_pk_bf16_f32 v38, v36, v37
    v_mfma_f32_16x16x32_bf16 v[176:179], v[74:77], v[44:47], v[224:227]
    v_cndmask_b32 v34, 0, v100, s[90:91]
    v_cndmask_b32 v35, 0, v101, s[90:91]
    v_mfma_f32_16x16x32_bf16 v[180:183], v[82:85], v[44:47], v[228:231]
    v_cndmask_b32 v36, 0, v100, s[92:93]
    v_cndmask_b32 v37, 0, v101, s[92:93]
    v_mfma_f32_16x16x32_bf16 v[184:187], v[64:67], v[32:35], v[224:227]
    v_cvt_pk_bf16_f32 v24, v24, v25
    v_cvt_pk_bf16_f32 v25, v26, v27
    v_mfma_f32_16x16x32_bf16 v[188:191], v[72:75], v[32:35], v[228:231]
    v_cvt_pk_bf16_f32 v31, v30, v31
    v_cvt_pk_bf16_f32 v30, v28, v29
    v_mfma_f32_16x16x32_bf16 v[192:195], v[66:69], v[36:39], v[224:227]
    v_cndmask_b32 v26, 0, v96, s[90:91]
    v_cndmask_b32 v27, 0, v97, s[90:91]
    v_mfma_f32_16x16x32_bf16 v[196:199], v[74:77], v[36:39], v[228:231]
    v_cndmask_b32 v28, 0, v96, s[92:93]
    v_cndmask_b32 v29, 0, v97, s[92:93]
    v_mfma_f32_16x16x32_bf16 v[200:203], v[56:59], v[24:27], v[224:227]
    v_cvt_pk_bf16_f32 v16, v16, v17
    v_cvt_pk_bf16_f32 v17, v18, v19
    v_mfma_f32_16x16x32_bf16 v[204:207], v[64:67], v[24:27], v[228:231]
    v_cvt_pk_bf16_f32 v23, v22, v23
    v_cvt_pk_bf16_f32 v22, v20, v21
    v_mfma_f32_16x16x32_bf16 v[208:211], v[58:61], v[28:31], v[224:227]
    v_cndmask_b32 v18, 0, v92, s[90:91]
    v_cndmask_b32 v19, 0, v93, s[90:91]
    v_mfma_f32_16x16x32_bf16 v[212:215], v[66:69], v[28:31], v[228:231]
    v_cndmask_b32 v20, 0, v92, s[92:93]
    v_cndmask_b32 v21, 0, v93, s[92:93]
    s_waitcnt lgkmcnt(0)
    v_mfma_f32_16x16x32_bf16 v[216:219], v[48:51], v[16:19], v[232:235]
    v_mfma_f32_16x16x32_bf16 v[220:223], v[56:59], v[16:19], v[228:231]
    v_mfma_f32_16x16x32_bf16 v[248:251], v[50:53], v[20:23], v[232:235]
    v_mfma_f32_16x16x32_bf16 v[252:255], v[58:61], v[20:23], v[228:231]
    v_max3_f32 v16, v168, v169, v172
    v_max3_f32 v17, v170, v171, v174
    v_max3_f32 v18, v176, v177, v180
    v_max3_f32 v19, v178, v179, v182
    v_max3_f32 v20, v184, v185, v188
    v_max3_f32 v21, v186, v187, v190
    v_max3_f32 v22, v192, v193, v196
    v_max3_f32 v23, v194, v195, v198
    v_max3_f32 v24, v200, v201, v204
    v_max3_f32 v25, v202, v203, v206
    v_max3_f32 v26, v208, v209, v212
    v_max3_f32 v27, v210, v211, v214
    v_max3_f32 v28, v216, v217, v220
    v_max3_f32 v29, v218, v219, v222
    v_max3_f32 v30, v248, v249, v252
    v_max3_f32 v31, v250, v251, v254
    v_max_f32 v16, v16, v173
    v_max_f32 v17, v17, v175
    v_max_f32 v18, v18, v181
    v_max_f32 v19, v19, v183
    v_max_f32 v20, v20, v189
    v_max_f32 v21, v21, v191
    v_max_f32 v22, v22, v197
    v_max_f32 v23, v23, v199
    v_max_f32 v24, v24, v205
    v_max_f32 v25, v25, v207
    v_max_f32 v26, v26, v213
    v_max_f32 v27, v27, v215
    v_max_f32 v28, v28, v221
    v_max_f32 v29, v29, v223
    v_max_f32 v30, v30, v253
    v_max_f32 v31, v31, v255
    v_max_f32 v32, v16, v17
    v_max_f32 v33, v18, v19
    v_max_f32 v34, v20, v21
    v_max_f32 v35, v22, v23
    v_max_f32 v36, v24, v25
    v_max_f32 v37, v26, v27
    v_max_f32 v38, v28, v29
    v_max_f32 v39, v30, v31
    v_permlane32_swap_b32 v32, v33
    v_permlane32_swap_b32 v34, v35
    v_permlane32_swap_b32 v36, v37
    v_permlane32_swap_b32 v38, v39
    v_max_f32 v32, v32, v33
    v_max_f32 v34, v34, v35
    v_max_f32 v36, v36, v37
    v_max_f32 v38, v38, v39
    v_permlane16_swap_b32 v32, v34
    s_nop 0
    v_permlane16_swap_b32 v36, v38
    v_max_f32 v32, v32, v34
    v_max_f32 v36, v36, v38
    v_mul_f32 v32, s31, v32
    v_mul_f32 v36, s31, v36
    v_mov_b32 v34, v32
    v_mov_b32 v38, v36
    s_nop 0
    v_permlane16_swap_b32 v32, v34
    v_permlane16_swap_b32 v36, v38
    v_mov_b32 v33, v32
    v_mov_b32 v35, v34
    v_mov_b32 v37, v36
    v_mov_b32 v39, v38
    v_permlane32_swap_b32 v32, v33
    v_permlane32_swap_b32 v34, v35
    v_permlane32_swap_b32 v36, v37
    v_permlane32_swap_b32 v38, v39
    v_pk_fma_f32 v[16:17], v[16:17], v[6:7], v[32:33] op_sel:[0,0,0] op_sel_hi:[1,0,0] neg_lo:[0,0,1] neg_hi:[0,0,1]
    v_pk_fma_f32 v[18:19], v[18:19], v[6:7], v[32:33] op_sel:[0,0,1] op_sel_hi:[1,0,1] neg_lo:[0,0,1] neg_hi:[0,0,1]
    v_pk_fma_f32 v[20:21], v[20:21], v[6:7], v[34:35] op_sel:[0,0,0] op_sel_hi:[1,0,0] neg_lo:[0,0,1] neg_hi:[0,0,1]
    v_pk_fma_f32 v[22:23], v[22:23], v[6:7], v[34:35] op_sel:[0,0,1] op_sel_hi:[1,0,1] neg_lo:[0,0,1] neg_hi:[0,0,1]
    v_pk_fma_f32 v[24:25], v[24:25], v[6:7], v[36:37] op_sel:[0,0,0] op_sel_hi:[1,0,0] neg_lo:[0,0,1] neg_hi:[0,0,1]
    v_pk_fma_f32 v[26:27], v[26:27], v[6:7], v[36:37] op_sel:[0,0,1] op_sel_hi:[1,0,1] neg_lo:[0,0,1] neg_hi:[0,0,1]
    v_pk_fma_f32 v[28:29], v[28:29], v[6:7], v[38:39] op_sel:[0,0,0] op_sel_hi:[1,0,0] neg_lo:[0,0,1] neg_hi:[0,0,1]
    v_pk_fma_f32 v[30:31], v[30:31], v[6:7], v[38:39] op_sel:[0,0,1] op_sel_hi:[1,0,1] neg_lo:[0,0,1] neg_hi:[0,0,1]
    v_exp_f32 v16, v16
    v_exp_f32 v17, v17
    v_exp_f32 v18, v18
    v_exp_f32 v19, v19
    v_exp_f32 v20, v20
    v_exp_f32 v21, v21
    v_exp_f32 v22, v22
    v_exp_f32 v23, v23
    v_exp_f32 v24, v24
    v_exp_f32 v25, v25
    v_exp_f32 v26, v26
    v_exp_f32 v27, v27
    v_exp_f32 v28, v28
    v_exp_f32 v29, v29
    v_exp_f32 v30, v30
    v_exp_f32 v31, v31
    v_add_f32 v32, v16, v17
    v_add_f32 v33, v18, v19
    v_add_f32 v34, v20, v21
    v_add_f32 v35, v22, v23
    v_add_f32 v36, v24, v25
    v_add_f32 v37, v26, v27
    v_add_f32 v38, v28, v29
    v_add_f32 v39, v30, v31
    v_permlane32_swap_b32 v32, v33
    v_permlane32_swap_b32 v34, v35
    v_permlane32_swap_b32 v36, v37
    v_permlane32_swap_b32 v38, v39
    v_add_f32 v32, v32, v33
    v_add_f32 v34, v34, v35
    v_add_f32 v36, v36, v37
    v_add_f32 v38, v38, v39
    v_permlane16_swap_b32 v32, v34
    s_nop 0
    v_permlane16_swap_b32 v36, v38
    v_add_f32 v32, v32, v34
    v_add_f32 v36, v36, v38
    v_rcp_f32 v32, v32
    v_rcp_f32 v36, v36
    v_mov_b32 v34, v32
    v_mov_b32 v38, v36
    s_nop 0
    v_permlane16_swap_b32 v32, v34
    v_permlane16_swap_b32 v36, v38
    v_mov_b32 v33, v32
    v_mov_b32 v35, v34
    v_mov_b32 v37, v36
    v_mov_b32 v39, v38
    v_permlane32_swap_b32 v32, v33
    v_permlane32_swap_b32 v34, v35
    v_permlane32_swap_b32 v36, v37
    v_permlane32_swap_b32 v38, v39
    v_pk_mul_f32 v[16:17], v[16:17], v[32:33] op_sel:[0,0] op_sel_hi:[1,0]
    v_pk_mul_f32 v[18:19], v[18:19], v[32:33] op_sel:[0,1] op_sel_hi:[1,1]
    v_pk_mul_f32 v[20:21], v[20:21], v[34:35] op_sel:[0,0] op_sel_hi:[1,0]
    v_pk_mul_f32 v[22:23], v[22:23], v[34:35] op_sel:[0,1] op_sel_hi:[1,1]
    v_pk_mul_f32 v[24:25], v[24:25], v[36:37] op_sel:[0,0] op_sel_hi:[1,0]
    v_pk_mul_f32 v[26:27], v[26:27], v[36:37] op_sel:[0,1] op_sel_hi:[1,1]
    v_pk_mul_f32 v[28:29], v[28:29], v[38:39] op_sel:[0,0] op_sel_hi:[1,0]
    v_pk_mul_f32 v[30:31], v[30:31], v[38:39] op_sel:[0,1] op_sel_hi:[1,1]
    v_cvt_pk_bf16_f32 v32, v16, v17
    v_cvt_pk_bf16_f32 v33, v18, v19
    v_cvt_pk_bf16_f32 v34, v20, v21
    v_cvt_pk_bf16_f32 v35, v22, v23
    v_cvt_pk_bf16_f32 v36, v24, v25
    v_cvt_pk_bf16_f32 v37, v26, v27
    v_cvt_pk_bf16_f32 v38, v28, v29
    v_cvt_pk_bf16_f32 v39, v30, v31
    s_setprio 2
    v_perm_b32 v48, v32, v32, v236
    v_perm_b32 v49, v32, v32, v237
    v_perm_b32 v50, v32, v32, v238
    v_perm_b32 v51, v32, v32, v239
    v_perm_b32 v52, v33, v33, v236
    v_perm_b32 v53, v33, v33, v237
    v_mfma_f32_16x16x32_bf16 v[168:171], v[114:117], v[48:51], 0
    v_perm_b32 v54, v33, v33, v238
    v_perm_b32 v55, v33, v33, v239
    v_mfma_f32_16x16x32_bf16 v[172:175], v[154:157], v[48:51], 0
    v_perm_b32 v56, v34, v34, v236
    v_perm_b32 v57, v34, v34, v237
    v_mfma_f32_16x16x32_bf16 v[176:179], v[134:137], v[52:55], 0
    v_perm_b32 v58, v34, v34, v238
    v_perm_b32 v59, v34, v34, v239
    v_mfma_f32_16x16x32_bf16 v[180:183], v[154:157], v[52:55], 0
    v_perm_b32 v60, v35, v35, v236
    v_perm_b32 v61, v35, v35, v237
    v_mfma_f32_16x16x32_bf16 v[184:187], v[112:115], v[56:59], 0
    v_perm_b32 v62, v35, v35, v238
    v_perm_b32 v63, v35, v35, v239
    v_mfma_f32_16x16x32_bf16 v[188:191], v[152:155], v[56:59], 0
    v_perm_b32 v64, v36, v36, v236
    v_perm_b32 v65, v36, v36, v237
    v_mfma_f32_16x16x32_bf16 v[192:195], v[132:135], v[60:63], 0
    v_perm_b32 v66, v36, v36, v238
    v_perm_b32 v67, v36, v36, v239
    v_mfma_f32_16x16x32_bf16 v[196:199], v[152:155], v[60:63], 0
    v_perm_b32 v68, v37, v37, v236
    v_perm_b32 v69, v37, v37, v237
    v_mfma_f32_16x16x32_bf16 v[200:203], v[110:113], v[64:67], 0
    v_perm_b32 v70, v37, v37, v238
    v_perm_b32 v71, v37, v37, v239
    v_mfma_f32_16x16x32_bf16 v[204:207], v[150:153], v[64:67], 0
    v_perm_b32 v72, v38, v38, v236
    v_perm_b32 v73, v38, v38, v237
    v_mfma_f32_16x16x32_bf16 v[208:211], v[130:133], v[68:71], 0
    v_perm_b32 v74, v38, v38, v238
    v_perm_b32 v75, v38, v38, v239
    v_mfma_f32_16x16x32_bf16 v[212:215], v[150:153], v[68:71], 0
    v_perm_b32 v76, v39, v39, v236
    v_perm_b32 v77, v39, v39, v237
    v_mfma_f32_16x16x32_bf16 v[216:219], v[108:111], v[72:75], 0
    v_perm_b32 v78, v39, v39, v238
    v_perm_b32 v79, v39, v39, v239
    v_mfma_f32_16x16x32_bf16 v[220:223], v[148:151], v[72:75], 0
    s_nop 0
    v_mfma_f32_16x16x32_bf16 v[248:251], v[128:131], v[76:79], 0
    v_mfma_f32_16x16x32_bf16 v[252:255], v[148:151], v[76:79], 0
    s_mov_b32 s29, 61440
    v_cvt_pk_bf16_f32 v16, v168, v169
    v_cvt_pk_bf16_f32 v17, v170, v171
    buffer_store_dwordx2 v[16:17], v12, s[4:7], s29 offen offset:0 sc1
    v_cvt_pk_bf16_f32 v18, v176, v177
    v_cvt_pk_bf16_f32 v19, v178, v179
    buffer_store_dwordx2 v[18:19], v12, s[4:7], s29 offen offset:512 sc1
    v_cndmask_b32 v172, v172, v180, s[94:95]
    v_cndmask_b32 v173, v173, v181, s[94:95]
    v_cndmask_b32 v174, v174, v182, s[94:95]
    v_cndmask_b32 v175, v175, v183, s[94:95]
    v_cvt_pk_bf16_f32 v20, v172, v173
    v_cvt_pk_bf16_f32 v21, v174, v175
    s_mov_b64 exec, s[96:97]
    buffer_store_dwordx2 v[20:21], v15, s[4:7], s29 offen offset:2048 sc1
    s_mov_b64 exec, -1
    s_mov_b32 s29, 40960
    v_cvt_pk_bf16_f32 v22, v184, v185
    v_cvt_pk_bf16_f32 v23, v186, v187
    buffer_store_dwordx2 v[22:23], v12, s[4:7], s29 offen offset:0 sc1
    v_cvt_pk_bf16_f32 v24, v192, v193
    v_cvt_pk_bf16_f32 v25, v194, v195
    buffer_store_dwordx2 v[24:25], v12, s[4:7], s29 offen offset:512 sc1
    v_cndmask_b32 v188, v188, v196, s[94:95]
    v_cndmask_b32 v189, v189, v197, s[94:95]
    v_cndmask_b32 v190, v190, v198, s[94:95]
    v_cndmask_b32 v191, v191, v199, s[94:95]
    v_cvt_pk_bf16_f32 v26, v188, v189
    v_cvt_pk_bf16_f32 v27, v190, v191
    s_mov_b64 exec, s[96:97]
    buffer_store_dwordx2 v[26:27], v15, s[4:7], s29 offen offset:2048 sc1
    s_mov_b64 exec, -1
    s_mov_b32 s29, 20480
    v_cvt_pk_bf16_f32 v28, v200, v201
    v_cvt_pk_bf16_f32 v29, v202, v203
    buffer_store_dwordx2 v[28:29], v12, s[4:7], s29 offen offset:0 sc1
    v_cvt_pk_bf16_f32 v30, v208, v209
    v_cvt_pk_bf16_f32 v31, v210, v211
    buffer_store_dwordx2 v[30:31], v12, s[4:7], s29 offen offset:512 sc1
    v_cndmask_b32 v204, v204, v212, s[94:95]
    v_cndmask_b32 v205, v205, v213, s[94:95]
    v_cndmask_b32 v206, v206, v214, s[94:95]
    v_cndmask_b32 v207, v207, v215, s[94:95]
    v_cvt_pk_bf16_f32 v32, v204, v205
    v_cvt_pk_bf16_f32 v33, v206, v207
    s_mov_b64 exec, s[96:97]
    buffer_store_dwordx2 v[32:33], v15, s[4:7], s29 offen offset:2048 sc1
    s_mov_b64 exec, -1
    s_mov_b32 s29, 0
    v_cvt_pk_bf16_f32 v34, v216, v217
    v_cvt_pk_bf16_f32 v35, v218, v219
    buffer_store_dwordx2 v[34:35], v12, s[4:7], s29 offen offset:0 sc1
    v_cvt_pk_bf16_f32 v36, v248, v249
    v_cvt_pk_bf16_f32 v37, v250, v251
    buffer_store_dwordx2 v[36:37], v12, s[4:7], s29 offen offset:512 sc1
    v_cndmask_b32 v220, v220, v252, s[94:95]
    v_cndmask_b32 v221, v221, v253, s[94:95]
    v_cndmask_b32 v222, v222, v254, s[94:95]
    v_cndmask_b32 v223, v223, v255, s[94:95]
    v_cvt_pk_bf16_f32 v38, v220, v221
    v_cvt_pk_bf16_f32 v39, v222, v223
    s_mov_b64 exec, s[96:97]
    buffer_store_dwordx2 v[38:39], v15, s[4:7], s29 offen offset:2048 sc1
    s_mov_b64 exec, -1
    s_waitcnt vmcnt(0)
    s_barrier
    s_cmp_lg_u32 s3, 0
    s_cbranch_scc1 Lqa_np
    s_mov_b64 exec, 3
    v_mov_b32 v3, s48
    buffer_store_dword v3, v14, s[44:47], 0 offen sc1
    s_mov_b64 exec, -1
Lqa_np:
Lp2_c1:
    s_load_dwordx2 s[24:25], s[0:1], 56
    s_load_dwordx2 s[28:29], s[0:1], 72
    s_and_b32 s27, s3, 2
    s_lshl_b32 s23, s50, 6
    s_lshl_b32 s26, s27, 4
    s_add_u32 s23, s23, s26
    v_and_b32 v2, 15, v1
    v_add_u32 v2, s23, v2
    v_lshlrev_b32 v3, 1, v2
    v_lshlrev_b32 v4, 3, v2
    s_and_b32 s22, s3, 1
    s_mul_i32 s22, s22, 3
    v_lshrrev_b32 v5, 2, v1
    v_lshrrev_b32 v6, 1, v5
    v_and_b32 v6, 3, v6
    v_xor_b32 v6, s27, v6
    v_lshlrev_b32 v6, 5, v6
    v_lshl_add_u32 v5, v5, 7, v6
    v_and_b32 v6, 3, v1
    v_lshl_add_u32 v8, v6, 3, v5
    v_xor_b32 v15, 32, v8
    s_lshl_b32 s23, s22, 10
    s_add_u32 s23, s23, 8192
    v_lshl_add_u32 v9, v1, 4, s23
    s_lshl_b32 s23, s27, 10
    v_lshl_add_u32 v13, v1, 3, s23
    v_mul_u32_u24 v12, 1280, v2
    v_lshrrev_b32 v6, 4, v1
    v_lshl_add_u32 v12, v6, 3, v12
    s_add_u32 s23, s22, s51
    s_lshl_b32 s23, s23, 5
    v_add_u32 v12, s23, v12
    v_and_b32 v14, 1, v6
    v_mul_u32_u24 v14, 24, v14
    v_add_u32 v14, v14, v12
    s_waitcnt lgkmcnt(0)
    s_mov_b32 s26, 4096
    s_mov_b32 s27, 0x20000
    s_add_u32 s8, s20, 8388608
    s_addc_u32 s9, s21, 0
    s_mov_b32 s10, 16384
    s_mov_b32 s11, 0x20000
    s_mov_b32 s30, 2621440
    s_mov_b32 s31, 0x20000
    buffer_load_ushort v10, v3, s[24:27], 0 offen
    buffer_load_ushort v11, v3, s[24:27], 0 offen offset:32
    s_setprio 0
    v_mov_b32 v44, 0
    v_mov_b32 v45, 0
    v_mov_b32 v46, 0
    v_mov_b32 v47, 0
    v_mov_b32 v48, 0
    v_mov_b32 v49, 0
    v_mov_b32 v50, 0
    v_mov_b32 v51, 0
    v_mov_b32 v52, 0
    v_mov_b32 v53, 0
    v_mov_b32 v54, 0
    v_mov_b32 v55, 0
    v_mov_b32 v56, 0
    v_mov_b32 v57, 0
    v_mov_b32 v58, 0
    v_mov_b32 v59, 0
    v_mov_b32 v60, 0
    v_mov_b32 v61, 0
    v_mov_b32 v62, 0
    v_mov_b32 v63, 0
    v_mov_b32 v64, 0
    v_mov_b32 v65, 0
    v_mov_b32 v66, 0
    v_mov_b32 v67, 0
    s_mov_b32 s33, 0
    s_mov_b32 s37, 0
    s_barrier
    ds_read_b64 v[68:69], v13 offset:0
    ds_read_b64 v[70:71], v13 offset:512
    ds_read_b128 v[76:79], v9 offset:0
    ds_read_b128 v[80:83], v9 offset:1024
    ds_read_b128 v[84:87], v9 offset:2048
    ds_read_b64 v[72:73], v13 offset:1024
    ds_read_b64 v[74:75], v13 offset:1536
    ds_read_b64 v[88:89], v13 offset:4096
    ds_read_b64 v[90:91], v13 offset:4608
    ds_read_b128 v[96:99], v9 offset:6144
    ds_read_b128 v[100:103], v9 offset:7168
    ds_read_b128 v[104:107], v9 offset:8192
    ds_read_b64 v[92:93], v13 offset:5120
    ds_read_b64 v[94:95], v13 offset:5632
    s_add_u32 s40, s37, 20480
    s_cmp_ge_u32 s40, 163840
    s_cselect_b32 s41, 0, s40
    s_sub_u32 s40, s41, s37
    s_mov_b32 s37, s41
    v_add_u32 v8, s40, v8
    v_add_u32 v15, s40, v15
    v_add_u32 v9, s40, v9
    v_add_u32 v13, s40, v13
.p2align 3
Lp216_ca:
    s_barrier
    ds_read_b64 v[108:109], v13 offset:0
    ds_read_b64 v[110:111], v13 offset:512
    s_waitcnt lgkmcnt(2)
    v_mfma_f32_16x16x32_bf16 v[44:47], v[76:79], v[68:71], v[44:47]
    ds_read_b128 v[116:119], v9 offset:0
    ds_read_b128 v[120:123], v9 offset:1024
    v_mfma_f32_16x16x32_bf16 v[48:51], v[80:83], v[68:71], v[48:51]
    ds_read_b128 v[124:127], v9 offset:2048
    ds_read_b64 v[112:113], v13 offset:1024
    v_mfma_f32_16x16x32_bf16 v[52:55], v[84:87], v[68:71], v[52:55]
    ds_read_b64 v[114:115], v13 offset:1536
    ds_read_b64 v[128:129], v13 offset:4096
    v_mfma_f32_16x16x32_bf16 v[56:59], v[76:79], v[72:75], v[56:59]
    ds_read_b64 v[130:131], v13 offset:4608
    ds_read_b128 v[136:139], v9 offset:6144
    v_mfma_f32_16x16x32_bf16 v[60:63], v[80:83], v[72:75], v[60:63]
    ds_read_b128 v[140:143], v9 offset:7168
    ds_read_b128 v[144:147], v9 offset:8192
    v_mfma_f32_16x16x32_bf16 v[64:67], v[84:87], v[72:75], v[64:67]
    ds_read_b64 v[132:133], v13 offset:5120
    ds_read_b64 v[134:135], v13 offset:5632
    v_mfma_f32_16x16x32_bf16 v[44:47], v[96:99], v[88:91], v[44:47]
    s_add_u32 s40, s37, 20480
    s_cmp_ge_u32 s40, 163840
    v_mfma_f32_16x16x32_bf16 v[48:51], v[100:103], v[88:91], v[48:51]
    s_cselect_b32 s41, 0, s40
    s_sub_u32 s40, s41, s37
    v_mfma_f32_16x16x32_bf16 v[52:55], v[104:107], v[88:91], v[52:55]
    s_mov_b32 s37, s41
    v_add_u32 v8, s40, v8
    v_mfma_f32_16x16x32_bf16 v[56:59], v[96:99], v[92:95], v[56:59]
    v_add_u32 v15, s40, v15
    v_add_u32 v9, s40, v9
    v_mfma_f32_16x16x32_bf16 v[60:63], v[100:103], v[92:95], v[60:63]
    v_add_u32 v13, s40, v13
    s_add_u32 s33, s33, 2
    v_mfma_f32_16x16x32_bf16 v[64:67], v[104:107], v[92:95], v[64:67]
    s_cmp_ge_u32 s33, 10
    s_barrier
    s_cbranch_scc1 Lp216_cax
    ds_read_b64 v[68:69], v13 offset:0
    ds_read_b64 v[70:71], v13 offset:512
    s_waitcnt lgkmcnt(2)
    v_mfma_f32_16x16x32_bf16 v[44:47], v[116:119], v[108:111], v[44:47]
    ds_read_b128 v[76:79], v9 offset:0
    ds_read_b128 v[80:83], v9 offset:1024
    v_mfma_f32_16x16x32_bf16 v[48:51], v[120:123], v[108:111], v[48:51]
    ds_read_b128 v[84:87], v9 offset:2048
    ds_read_b64 v[72:73], v13 offset:1024
    v_mfma_f32_16x16x32_bf16 v[52:55], v[124:127], v[108:111], v[52:55]
    ds_read_b64 v[74:75], v13 offset:1536
    ds_read_b64 v[88:89], v13 offset:4096
    v_mfma_f32_16x16x32_bf16 v[56:59], v[116:119], v[112:115], v[56:59]
    ds_read_b64 v[90:91], v13 offset:4608
    ds_read_b128 v[96:99], v9 offset:6144
    v_mfma_f32_16x16x32_bf16 v[60:63], v[120:123], v[112:115], v[60:63]
    ds_read_b128 v[100:103], v9 offset:7168
    ds_read_b128 v[104:107], v9 offset:8192
    v_mfma_f32_16x16x32_bf16 v[64:67], v[124:127], v[112:115], v[64:67]
    ds_read_b64 v[92:93], v13 offset:5120
    ds_read_b64 v[94:95], v13 offset:5632
    v_mfma_f32_16x16x32_bf16 v[44:47], v[136:139], v[128:131], v[44:47]
    s_add_u32 s40, s37, 20480
    s_cmp_ge_u32 s40, 163840
    v_mfma_f32_16x16x32_bf16 v[48:51], v[140:143], v[128:131], v[48:51]
    s_cselect_b32 s41, 0, s40
    s_sub_u32 s40, s41, s37
    v_mfma_f32_16x16x32_bf16 v[52:55], v[144:147], v[128:131], v[52:55]
    s_mov_b32 s37, s41
    v_add_u32 v8, s40, v8
    v_mfma_f32_16x16x32_bf16 v[56:59], v[136:139], v[132:135], v[56:59]
    v_add_u32 v15, s40, v15
    v_add_u32 v9, s40, v9
    v_mfma_f32_16x16x32_bf16 v[60:63], v[140:143], v[132:135], v[60:63]
    v_add_u32 v13, s40, v13
    v_mfma_f32_16x16x32_bf16 v[64:67], v[144:147], v[132:135], v[64:67]
    s_branch Lp216_ca
Lp216_cax:
    ds_read_b64_tr_b16 v[68:69], v8 offset:0
    ds_read_b64_tr_b16 v[70:71], v8 offset:2048
    s_waitcnt lgkmcnt(2)
    v_mfma_f32_16x16x32_bf16 v[44:47], v[116:119], v[108:111], v[44:47]
    ds_read_b128 v[76:79], v9 offset:0
    ds_read_b128 v[80:83], v9 offset:1024
    v_mfma_f32_16x16x32_bf16 v[48:51], v[120:123], v[108:111], v[48:51]
    ds_read_b128 v[84:87], v9 offset:2048
    ds_read_b64_tr_b16 v[72:73], v15 offset:0
    v_mfma_f32_16x16x32_bf16 v[52:55], v[124:127], v[108:111], v[52:55]
    ds_read_b64_tr_b16 v[74:75], v15 offset:2048
    ds_read_b64_tr_b16 v[88:89], v8 offset:4096
    v_mfma_f32_16x16x32_bf16 v[56:59], v[116:119], v[112:115], v[56:59]
    ds_read_b64_tr_b16 v[90:91], v8 offset:6144
    ds_read_b128 v[96:99], v9 offset:6144
    v_mfma_f32_16x16x32_bf16 v[60:63], v[120:123], v[112:115], v[60:63]
    ds_read_b128 v[100:103], v9 offset:7168
    ds_read_b128 v[104:107], v9 offset:8192
    v_mfma_f32_16x16x32_bf16 v[64:67], v[124:127], v[112:115], v[64:67]
    ds_read_b64_tr_b16 v[92:93], v15 offset:4096
    ds_read_b64_tr_b16 v[94:95], v15 offset:6144
    v_mfma_f32_16x16x32_bf16 v[44:47], v[136:139], v[128:131], v[44:47]
    s_add_u32 s40, s37, 20480
    s_cmp_ge_u32 s40, 163840
    v_mfma_f32_16x16x32_bf16 v[48:51], v[140:143], v[128:131], v[48:51]
    s_cselect_b32 s41, 0, s40
    s_sub_u32 s40, s41, s37
    v_mfma_f32_16x16x32_bf16 v[52:55], v[144:147], v[128:131], v[52:55]
    s_mov_b32 s37, s41
    v_add_u32 v8, s40, v8
    v_mfma_f32_16x16x32_bf16 v[56:59], v[136:139], v[132:135], v[56:59]
    v_add_u32 v15, s40, v15
    v_add_u32 v9, s40, v9
    v_mfma_f32_16x16x32_bf16 v[60:63], v[140:143], v[132:135], v[60:63]
    v_mfma_f32_16x16x32_bf16 v[64:67], v[144:147], v[132:135], v[64:67]
    s_waitcnt vmcnt(0)
    buffer_load_dwordx2 v[16:17], v4, s[8:11], 0 offen sc1
    buffer_load_dwordx2 v[18:19], v4, s[8:11], 0 offen offset:128 sc1
    v_lshlrev_b32 v10, 16, v10
    v_lshlrev_b32 v11, 16, v11
    v_mov_b32 v20, v10
    v_mov_b32 v21, v10
    v_mov_b32 v22, v10
    v_mov_b32 v23, v10
    v_mov_b32 v24, v10
    v_mov_b32 v25, v10
    v_mov_b32 v26, v10
    v_mov_b32 v27, v10
    v_mov_b32 v28, v10
    v_mov_b32 v29, v10
    v_mov_b32 v30, v10
    v_mov_b32 v31, v10
    v_mov_b32 v32, v11
    v_mov_b32 v33, v11
    v_mov_b32 v34, v11
    v_mov_b32 v35, v11
    v_mov_b32 v36, v11
    v_mov_b32 v37, v11
    v_mov_b32 v38, v11
    v_mov_b32 v39, v11
    v_mov_b32 v40, v11
    v_mov_b32 v41, v11
    v_mov_b32 v42, v11
    v_mov_b32 v43, v11
.p2align 3
Lp216_cb:
    s_barrier
    ds_read_b64_tr_b16 v[108:109], v8 offset:0
    ds_read_b64_tr_b16 v[110:111], v8 offset:2048
    s_waitcnt lgkmcnt(2)
    v_mfma_f32_16x16x32_bf16 v[20:23], v[76:79], v[68:71], v[20:23]
    ds_read_b128 v[116:119], v9 offset:0
    ds_read_b128 v[120:123], v9 offset:1024
    v_mfma_f32_16x16x32_bf16 v[24:27], v[80:83], v[68:71], v[24:27]
    ds_read_b128 v[124:127], v9 offset:2048
    ds_read_b64_tr_b16 v[112:113], v15 offset:0
    v_mfma_f32_16x16x32_bf16 v[28:31], v[84:87], v[68:71], v[28:31]
    ds_read_b64_tr_b16 v[114:115], v15 offset:2048
    ds_read_b64_tr_b16 v[128:129], v8 offset:4096
    v_mfma_f32_16x16x32_bf16 v[32:35], v[76:79], v[72:75], v[32:35]
    ds_read_b64_tr_b16 v[130:131], v8 offset:6144
    ds_read_b128 v[136:139], v9 offset:6144
    v_mfma_f32_16x16x32_bf16 v[36:39], v[80:83], v[72:75], v[36:39]
    ds_read_b128 v[140:143], v9 offset:7168
    ds_read_b128 v[144:147], v9 offset:8192
    v_mfma_f32_16x16x32_bf16 v[40:43], v[84:87], v[72:75], v[40:43]
    ds_read_b64_tr_b16 v[132:133], v15 offset:4096
    ds_read_b64_tr_b16 v[134:135], v15 offset:6144
    v_mfma_f32_16x16x32_bf16 v[20:23], v[96:99], v[88:91], v[20:23]
    s_add_u32 s40, s37, 20480
    s_cmp_ge_u32 s40, 163840
    v_mfma_f32_16x16x32_bf16 v[24:27], v[100:103], v[88:91], v[24:27]
    s_cselect_b32 s41, 0, s40
    s_sub_u32 s40, s41, s37
    v_mfma_f32_16x16x32_bf16 v[28:31], v[104:107], v[88:91], v[28:31]
    s_mov_b32 s37, s41
    v_add_u32 v8, s40, v8
    v_mfma_f32_16x16x32_bf16 v[32:35], v[96:99], v[92:95], v[32:35]
    v_add_u32 v15, s40, v15
    v_add_u32 v9, s40, v9
    v_mfma_f32_16x16x32_bf16 v[36:39], v[100:103], v[92:95], v[36:39]
    s_add_u32 s33, s33, 2
    s_cmp_ge_u32 s33, 34
    v_mfma_f32_16x16x32_bf16 v[40:43], v[104:107], v[92:95], v[40:43]
    s_cbranch_scc1 Lp216_clast
    s_barrier
    ds_read_b64_tr_b16 v[68:69], v8 offset:0
    ds_read_b64_tr_b16 v[70:71], v8 offset:2048
    s_waitcnt lgkmcnt(2)
    v_mfma_f32_16x16x32_bf16 v[20:23], v[116:119], v[108:111], v[20:23]
    ds_read_b128 v[76:79], v9 offset:0
    ds_read_b128 v[80:83], v9 offset:1024
    v_mfma_f32_16x16x32_bf16 v[24:27], v[120:123], v[108:111], v[24:27]
    ds_read_b128 v[84:87], v9 offset:2048
    ds_read_b64_tr_b16 v[72:73], v15 offset:0
    v_mfma_f32_16x16x32_bf16 v[28:31], v[124:127], v[108:111], v[28:31]
    ds_read_b64_tr_b16 v[74:75], v15 offset:2048
    ds_read_b64_tr_b16 v[88:89], v8 offset:4096
    v_mfma_f32_16x16x32_bf16 v[32:35], v[116:119], v[112:115], v[32:35]
    ds_read_b64_tr_b16 v[90:91], v8 offset:6144
    ds_read_b128 v[96:99], v9 offset:6144
    v_mfma_f32_16x16x32_bf16 v[36:39], v[120:123], v[112:115], v[36:39]
    ds_read_b128 v[100:103], v9 offset:7168
    ds_read_b128 v[104:107], v9 offset:8192
    v_mfma_f32_16x16x32_bf16 v[40:43], v[124:127], v[112:115], v[40:43]
    ds_read_b64_tr_b16 v[92:93], v15 offset:4096
    ds_read_b64_tr_b16 v[94:95], v15 offset:6144
    v_mfma_f32_16x16x32_bf16 v[20:23], v[136:139], v[128:131], v[20:23]
    s_add_u32 s40, s37, 20480
    s_cmp_ge_u32 s40, 163840
    v_mfma_f32_16x16x32_bf16 v[24:27], v[140:143], v[128:131], v[24:27]
    s_cselect_b32 s41, 0, s40
    s_sub_u32 s40, s41, s37
    v_mfma_f32_16x16x32_bf16 v[28:31], v[144:147], v[128:131], v[28:31]
    s_mov_b32 s37, s41
    v_add_u32 v8, s40, v8
    v_mfma_f32_16x16x32_bf16 v[32:35], v[136:139], v[132:135], v[32:35]
    v_add_u32 v15, s40, v15
    v_add_u32 v9, s40, v9
    v_mfma_f32_16x16x32_bf16 v[36:39], v[140:143], v[132:135], v[36:39]
    v_mfma_f32_16x16x32_bf16 v[40:43], v[144:147], v[132:135], v[40:43]
    s_branch Lp216_cb
Lp216_clast:
    s_waitcnt lgkmcnt(11)
    v_mfma_f32_16x16x32_bf16 v[20:23], v[116:119], v[108:111], v[20:23]
    s_waitcnt lgkmcnt(10)
    v_mfma_f32_16x16x32_bf16 v[24:27], v[120:123], v[108:111], v[24:27]
    s_waitcnt lgkmcnt(9)
    v_mfma_f32_16x16x32_bf16 v[28:31], v[124:127], v[108:111], v[28:31]
    s_waitcnt lgkmcnt(7)
    v_mfma_f32_16x16x32_bf16 v[32:35], v[116:119], v[112:115], v[32:35]
    v_mfma_f32_16x16x32_bf16 v[36:39], v[120:123], v[112:115], v[36:39]
    v_mfma_f32_16x16x32_bf16 v[40:43], v[124:127], v[112:115], v[40:43]
    s_waitcnt lgkmcnt(4)
    v_mfma_f32_16x16x32_bf16 v[20:23], v[136:139], v[128:131], v[20:23]
    s_waitcnt lgkmcnt(3)
    v_mfma_f32_16x16x32_bf16 v[24:27], v[140:143], v[128:131], v[24:27]
    s_waitcnt lgkmcnt(2)
    v_mfma_f32_16x16x32_bf16 v[28:31], v[144:147], v[128:131], v[28:31]
    s_waitcnt lgkmcnt(0)
    v_mfma_f32_16x16x32_bf16 v[32:35], v[136:139], v[132:135], v[32:35]
    v_mfma_f32_16x16x32_bf16 v[36:39], v[140:143], v[132:135], v[36:39]
    v_mfma_f32_16x16x32_bf16 v[40:43], v[144:147], v[132:135], v[40:43]
    s_mov_b32 s49, 0
    s_mov_b32 s22, 20480
Lp216_g:
    s_waitcnt vmcnt(0)
    v_cmp_ne_u32 vcc, s48, v17
    v_cmp_ne_u32 s[26:27], s48, v19
    s_add_u32 s49, s49, 1
    s_or_b64 vcc, vcc, s[26:27]
    s_cbranch_scc0 Lp216_gk
    buffer_load_dwordx2 v[16:17], v4, s[8:11], 0 offen sc1
    buffer_load_dwordx2 v[18:19], v4, s[8:11], 0 offen offset:128 sc1
    s_cmp_lt_u32 s49, 20000
    s_cbranch_scc1 Lp216_g
    s_waitcnt vmcnt(0)
Lp216_gk:
    v_pk_add_f32 v[44:45], v[44:45], v[20:21] neg_lo:[0,1] neg_hi:[0,1]
    v_pk_add_f32 v[46:47], v[46:47], v[22:23] neg_lo:[0,1] neg_hi:[0,1]
    v_pk_fma_f32 v[20:21], v[44:45], v[16:17], v[20:21] op_sel_hi:[1,0,1]
    v_pk_fma_f32 v[22:23], v[46:47], v[16:17], v[22:23] op_sel_hi:[1,0,1]
    v_cvt_pk_bf16_f32 v68, v20, v21
    v_cvt_pk_bf16_f32 v69, v22, v23
    v_pk_add_f32 v[48:49], v[48:49], v[24:25] neg_lo:[0,1] neg_hi:[0,1]
    v_pk_add_f32 v[50:51], v[50:51], v[26:27] neg_lo:[0,1] neg_hi:[0,1]
    v_pk_fma_f32 v[24:25], v[48:49], v[16:17], v[24:25] op_sel_hi:[1,0,1]
    v_pk_fma_f32 v[26:27], v[50:51], v[16:17], v[26:27] op_sel_hi:[1,0,1]
    v_cvt_pk_bf16_f32 v70, v24, v25
    v_cvt_pk_bf16_f32 v71, v26, v27
    s_nop 0
    v_permlane16_swap_b32 v68, v70
    v_permlane16_swap_b32 v69, v71
    buffer_store_dwordx4 v[68:71], v14, s[28:31], 0 offen
    v_pk_add_f32 v[52:53], v[52:53], v[28:29] neg_lo:[0,1] neg_hi:[0,1]
    v_pk_add_f32 v[54:55], v[54:55], v[30:31] neg_lo:[0,1] neg_hi:[0,1]
    v_pk_fma_f32 v[28:29], v[52:53], v[16:17], v[28:29] op_sel_hi:[1,0,1]
    v_pk_fma_f32 v[30:31], v[54:55], v[16:17], v[30:31] op_sel_hi:[1,0,1]
    v_cvt_pk_bf16_f32 v72, v28, v29
    v_cvt_pk_bf16_f32 v73, v30, v31
    buffer_store_dwordx2 v[72:73], v12, s[28:31], 0 offen offset:64
    v_pk_add_f32 v[56:57], v[56:57], v[32:33] neg_lo:[0,1] neg_hi:[0,1]
    v_pk_add_f32 v[58:59], v[58:59], v[34:35] neg_lo:[0,1] neg_hi:[0,1]
    v_pk_fma_f32 v[32:33], v[56:57], v[18:19], v[32:33] op_sel_hi:[1,0,1]
    v_pk_fma_f32 v[34:35], v[58:59], v[18:19], v[34:35] op_sel_hi:[1,0,1]
    v_cvt_pk_bf16_f32 v76, v32, v33
    v_cvt_pk_bf16_f32 v77, v34, v35
    v_pk_add_f32 v[60:61], v[60:61], v[36:37] neg_lo:[0,1] neg_hi:[0,1]
    v_pk_add_f32 v[62:63], v[62:63], v[38:39] neg_lo:[0,1] neg_hi:[0,1]
    v_pk_fma_f32 v[36:37], v[60:61], v[18:19], v[36:37] op_sel_hi:[1,0,1]
    v_pk_fma_f32 v[38:39], v[62:63], v[18:19], v[38:39] op_sel_hi:[1,0,1]
    v_cvt_pk_bf16_f32 v78, v36, v37
    v_cvt_pk_bf16_f32 v79, v38, v39
    s_nop 0
    v_permlane16_swap_b32 v76, v78
    v_permlane16_swap_b32 v77, v79
    buffer_store_dwordx4 v[76:79], v14, s[28:31], s22 offen
    v_pk_add_f32 v[64:65], v[64:65], v[40:41] neg_lo:[0,1] neg_hi:[0,1]
    v_pk_add_f32 v[66:67], v[66:67], v[42:43] neg_lo:[0,1] neg_hi:[0,1]
    v_pk_fma_f32 v[40:41], v[64:65], v[18:19], v[40:41] op_sel_hi:[1,0,1]
    v_pk_fma_f32 v[42:43], v[66:67], v[18:19], v[42:43] op_sel_hi:[1,0,1]
    v_cvt_pk_bf16_f32 v80, v40, v41
    v_cvt_pk_bf16_f32 v81, v42, v43
    buffer_store_dwordx2 v[80:81], v12, s[28:31], s22 offen offset:64
    s_endpgm
Lp2_s1:
    s_load_dwordx2 s[12:13], s[0:1], 48
    v_lshrrev_b32 v2, 3, v1
    v_and_b32 v3, 7, v1
    v_and_b32 v4, 6, v2
    v_xor_b32 v3, v3, v4
    v_lshlrev_b32 v3, 4, v3
    v_lshl_add_u32 v2, v2, 12, v3
    s_lshl_b32 s23, s3, 17
    s_lshl_b32 s26, s50, 7
    s_add_u32 s23, s23, s26
    v_add_u32 v8, s23, v2
    v_add_u32 v9, 32768, v8
    v_add_u32 v10, 65536, v8
    v_add_u32 v11, 98304, v8
    s_lshl_b32 s23, s50, 2
    s_mul_i32 s23, s23, 40
    s_lshl_b32 s26, s3, 1
    s_add_u32 s23, s23, s26
    s_lshl_b32 s23, s23, 9
    v_lshl_add_u32 v16, v1, 4, s23
    v_add_u32 v17, 20480, v16
    v_add_u32 v18, 40960, v16
    v_add_u32 v19, 61440, v16
    s_and_b32 s23, s50, -2
    s_add_u32 s23, s23, 1
    s_lshl_b32 s23, s23, 10
    s_add_u32 s23, s23, 131072
    v_lshl_add_u32 v12, v1, 7, s23
    s_mov_b32 s34, 0
    s_lshl_b32 s37, s3, 12
    s_add_u32 s38, s37, 163840
    s_mov_b32 s33, 0
    s_waitcnt lgkmcnt(0)
    s_add_u32 s4, s20, 2621440
    s_addc_u32 s5, s21, 0
    s_mov_b32 s6, 2621440
    s_mov_b32 s7, 0x20000
Lp2_s16e:
    s_barrier
    s_mov_b32 s49, 0
    s_mov_b32 exec_lo, 255
    s_mov_b32 exec_hi, 0
Lg18:
    buffer_load_dword v2, v12, s[44:47], 0 offen sc1
    s_waitcnt vmcnt(0)
    v_xor_b32 v2, s48, v2
    v_cmp_ne_u32 vcc, 0, v2
    s_add_u32 s49, s49, 1
    s_cmp_eq_u64 vcc, 0
    s_cbranch_scc1 Lg18d
    s_sleep 2
    s_cmp_lt_u32 s49, 20000
    s_cbranch_scc1 Lg18
Lg18d:
    s_mov_b64 exec, -1
Lp2_s16k:
    s_add_u32 s32, s33, 6
Li19:
    s_lshl_b32 s40, s34, 11
    s_add_u32 m0, s37, 0
    s_nop 0
    buffer_load_dwordx4 v16, s[4:7], s40 offen sc1 lds
    s_add_u32 m0, s37, 1024
    s_nop 0
    buffer_load_dwordx4 v17, s[4:7], s40 offen sc1 lds
    s_add_u32 m0, s37, 2048
    s_nop 0
    buffer_load_dwordx4 v18, s[4:7], s40 offen sc1 lds
    s_add_u32 m0, s37, 3072
    s_nop 0
    buffer_load_dwordx4 v19, s[4:7], s40 offen sc1 lds
    s_add_u32 s37, s37, 20480
    s_cmp_ge_u32 s37, s38
    s_cselect_b32 s42, 163840, 0
    s_sub_u32 s37, s37, s42
    s_add_u32 s34, s34, 1
    s_add_u32 s33, s33, 1
    s_cmp_lt_u32 s33, s32
    s_cbranch_scc1 Li19
Ls20:
    s_waitcnt vmcnt(20)
    s_barrier
    s_lshl_b32 s40, s34, 11
    s_add_u32 m0, s37, 0
    s_nop 0
    buffer_load_dwordx4 v16, s[4:7], s40 offen sc1 lds
    s_add_u32 m0, s37, 1024
    s_nop 0
    buffer_load_dwordx4 v17, s[4:7], s40 offen sc1 lds
    s_add_u32 m0, s37, 2048
    s_nop 0
    buffer_load_dwordx4 v18, s[4:7], s40 offen sc1 lds
    s_add_u32 m0, s37, 3072
    s_nop 0
    buffer_load_dwordx4 v19, s[4:7], s40 offen sc1 lds
    s_add_u32 s37, s37, 20480
    s_cmp_ge_u32 s37, s38
    s_cselect_b32 s42, 163840, 0
    s_sub_u32 s37, s37, s42
    s_add_u32 s34, s34, 1
    s_add_u32 s33, s33, 1
    s_cmp_lt_u32 s33, 10
    s_cbranch_scc1 Ls20
    s_mov_b32 s4, s12
    s_mov_b32 s5, s13
    s_mov_b32 s6, 6291456
    s_mov_b32 s7, 0x20000
    s_mov_b32 s34, 0
Ls21:
    s_waitcnt vmcnt(20)
    s_barrier
    s_lshl_b32 s40, s34, 18
    s_add_u32 m0, s37, 0
    s_nop 0
    buffer_load_dwordx4 v8, s[4:7], s40 offen  lds
    s_add_u32 m0, s37, 1024
    s_nop 0
    buffer_load_dwordx4 v9, s[4:7], s40 offen  lds
    s_add_u32 m0, s37, 2048
    s_nop 0
    buffer_load_dwordx4 v10, s[4:7], s40 offen  lds
    s_add_u32 m0, s37, 3072
    s_nop 0
    buffer_load_dwordx4 v11, s[4:7], s40 offen  lds
    s_add_u32 s37, s37, 20480
    s_cmp_ge_u32 s37, s38
    s_cselect_b32 s42, 163840, 0
    s_sub_u32 s37, s37, s42
    s_add_u32 s34, s34, 1
    s_add_u32 s33, s33, 1
    s_cmp_lt_u32 s33, 34
    s_cbranch_scc1 Ls21
    s_waitcnt vmcnt(20)
    s_barrier
    s_waitcnt vmcnt(16)
    s_barrier
    s_waitcnt vmcnt(12)
    s_barrier
    s_waitcnt vmcnt(8)
    s_barrier
    s_waitcnt vmcnt(4)
    s_barrier
    s_waitcnt vmcnt(0)
    s_barrier
    s_endpgm
Lp2_d1:
    s_sub_u32 s22, s3, 2
    s_mul_i32 s23, s51, 68
    s_add_u32 s23, s23, s22
    s_lshl_b32 s23, s23, 10
    v_lshl_add_u32 v8, v1, 4, s23
    v_add_u32 v9, 69632, v8
    v_add_u32 v10, 139264, v8
    v_add_u32 v11, 208896, v8
    v_add_u32 v12, 278528, v8
    v_add_u32 v13, 348160, v8
    s_mul_i32 s37, s22, 6144
    s_add_u32 s37, s37, 8192
    s_add_u32 s38, s37, 163840
    s_lshl_b32 s23, s52, 10
    s_add_u32 s23, s23, 327680
    v_lshl_add_u32 v16, v1, 7, s23
    s_lshr_b32 s23, s51, 2
    s_lshl_b32 s23, s23, 11
    s_lshr_b32 s26, s52, 1
    s_mul_i32 s26, s26, 20480
    s_add_u32 s23, s23, s26
    s_add_u32 s23, s23, 163840
    v_lshl_add_u32 v17, v1, 7, s23
    s_mov_b32 s34, 0
    s_mov_b32 s36, 48
    s_mov_b32 s33, 0
    s_add_u32 s8, s20, 5242880
    s_addc_u32 s9, s21, 0
    s_mov_b32 s10, 2785280
    s_mov_b32 s11, 0x20000
Lp2_d16e:
    s_mov_b32 s49, 0
    s_mov_b32 exec_lo, 255
    s_mov_b32 exec_hi, 0
Lg22:
    buffer_load_dword v2, v16, s[44:47], 0 offen sc1
    s_waitcnt vmcnt(0)
    v_xor_b32 v2, s48, v2
    v_cmp_ne_u32 vcc, 0, v2
    s_add_u32 s49, s49, 1
    s_cmp_eq_u64 vcc, 0
    s_cbranch_scc1 Lg22d
    s_sleep 8
    s_cmp_lt_u32 s49, 20000
    s_cbranch_scc1 Lg22
Lg22d:
    s_mov_b64 exec, -1
    s_barrier
Lp2_d16k:
    s_add_u32 s32, s33, 6
Li23:
    s_lshl_b32 s41, s34, 1
    s_add_u32 s41, s41, s36
    s_lshl_b32 s41, s41, 10
    s_add_u32 m0, s37, 0
    s_nop 0
    buffer_load_dwordx4 v8, s[8:11], s41 offen sc1 lds
    s_add_u32 m0, s37, 1024
    s_nop 0
    buffer_load_dwordx4 v9, s[8:11], s41 offen sc1 lds
    s_add_u32 m0, s37, 2048
    s_nop 0
    buffer_load_dwordx4 v10, s[8:11], s41 offen sc1 lds
    s_add_u32 m0, s37, 3072
    s_nop 0
    buffer_load_dwordx4 v11, s[8:11], s41 offen sc1 lds
    s_add_u32 m0, s37, 4096
    s_nop 0
    buffer_load_dwordx4 v12, s[8:11], s41 offen sc1 lds
    s_add_u32 m0, s37, 5120
    s_nop 0
    buffer_load_dwordx4 v13, s[8:11], s41 offen sc1 lds
    s_add_u32 s37, s37, 20480
    s_cmp_ge_u32 s37, s38
    s_cselect_b32 s42, 163840, 0
    s_sub_u32 s37, s37, s42
    s_add_u32 s34, s34, 1
    s_add_u32 s33, s33, 1
    s_cmp_lt_u32 s33, s32
    s_cbranch_scc1 Li23
Ls24:
    s_waitcnt vmcnt(30)
    s_barrier
    s_lshl_b32 s41, s34, 1
    s_add_u32 s41, s41, s36
    s_lshl_b32 s41, s41, 10
    s_add_u32 m0, s37, 0
    s_nop 0
    buffer_load_dwordx4 v8, s[8:11], s41 offen sc1 lds
    s_add_u32 m0, s37, 1024
    s_nop 0
    buffer_load_dwordx4 v9, s[8:11], s41 offen sc1 lds
    s_add_u32 m0, s37, 2048
    s_nop 0
    buffer_load_dwordx4 v10, s[8:11], s41 offen sc1 lds
    s_add_u32 m0, s37, 3072
    s_nop 0
    buffer_load_dwordx4 v11, s[8:11], s41 offen sc1 lds
    s_add_u32 m0, s37, 4096
    s_nop 0
    buffer_load_dwordx4 v12, s[8:11], s41 offen sc1 lds
    s_add_u32 m0, s37, 5120
    s_nop 0
    buffer_load_dwordx4 v13, s[8:11], s41 offen sc1 lds
    s_add_u32 s37, s37, 20480
    s_cmp_ge_u32 s37, s38
    s_cselect_b32 s42, 163840, 0
    s_sub_u32 s37, s37, s42
    s_add_u32 s34, s34, 1
    s_add_u32 s33, s33, 1
    s_cmp_lt_u32 s33, 10
    s_cbranch_scc1 Ls24
    s_waitcnt vmcnt(30)
    s_barrier
    s_mov_b32 s36, 0
    s_mov_b32 s34, 0
    s_mov_b32 s49, 0
    s_mov_b32 exec_lo, 268374015
    s_mov_b32 exec_hi, 0
Lg25:
    buffer_load_dword v2, v17, s[44:47], 0 offen sc1
    s_waitcnt vmcnt(0)
    v_xor_b32 v2, s48, v2
    v_cmp_ne_u32 vcc, 0, v2
    s_add_u32 s49, s49, 1
    s_cmp_eq_u64 vcc, 0
    s_cbranch_scc1 Lg25d
    s_sleep 2
    s_cmp_lt_u32 s49, 20000
    s_cbranch_scc1 Lg25
Lg25d:
    s_mov_b64 exec, -1
    s_add_u32 s32, s33, 1
Li26:
    s_lshl_b32 s41, s34, 1
    s_add_u32 s41, s41, s36
    s_lshl_b32 s41, s41, 10
    s_add_u32 m0, s37, 0
    s_nop 0
    buffer_load_dwordx4 v8, s[8:11], s41 offen sc1 lds
    s_add_u32 m0, s37, 1024
    s_nop 0
    buffer_load_dwordx4 v9, s[8:11], s41 offen sc1 lds
    s_add_u32 m0, s37, 2048
    s_nop 0
    buffer_load_dwordx4 v10, s[8:11], s41 offen sc1 lds
    s_add_u32 m0, s37, 3072
    s_nop 0
    buffer_load_dwordx4 v11, s[8:11], s41 offen sc1 lds
    s_add_u32 m0, s37, 4096
    s_nop 0
    buffer_load_dwordx4 v12, s[8:11], s41 offen sc1 lds
    s_add_u32 m0, s37, 5120
    s_nop 0
    buffer_load_dwordx4 v13, s[8:11], s41 offen sc1 lds
    s_add_u32 s37, s37, 20480
    s_cmp_ge_u32 s37, s38
    s_cselect_b32 s42, 163840, 0
    s_sub_u32 s37, s37, s42
    s_add_u32 s34, s34, 1
    s_add_u32 s33, s33, 1
    s_cmp_lt_u32 s33, s32
    s_cbranch_scc1 Li26
Ls27:
    s_waitcnt vmcnt(30)
    s_barrier
    s_lshl_b32 s41, s34, 1
    s_add_u32 s41, s41, s36
    s_lshl_b32 s41, s41, 10
    s_add_u32 m0, s37, 0
    s_nop 0
    buffer_load_dwordx4 v8, s[8:11], s41 offen sc1 lds
    s_add_u32 m0, s37, 1024
    s_nop 0
    buffer_load_dwordx4 v9, s[8:11], s41 offen sc1 lds
    s_add_u32 m0, s37, 2048
    s_nop 0
    buffer_load_dwordx4 v10, s[8:11], s41 offen sc1 lds
    s_add_u32 m0, s37, 3072
    s_nop 0
    buffer_load_dwordx4 v11, s[8:11], s41 offen sc1 lds
    s_add_u32 m0, s37, 4096
    s_nop 0
    buffer_load_dwordx4 v12, s[8:11], s41 offen sc1 lds
    s_add_u32 m0, s37, 5120
    s_nop 0
    buffer_load_dwordx4 v13, s[8:11], s41 offen sc1 lds
    s_add_u32 s37, s37, 20480
    s_cmp_ge_u32 s37, s38
    s_cselect_b32 s42, 163840, 0
    s_sub_u32 s37, s37, s42
    s_add_u32 s34, s34, 1
    s_add_u32 s33, s33, 1
    s_cmp_lt_u32 s33, 34
    s_cbranch_scc1 Ls27
    s_waitcnt vmcnt(30)
    s_barrier
    s_waitcnt vmcnt(24)
    s_barrier
    s_waitcnt vmcnt(18)
    s_barrier
    s_waitcnt vmcnt(12)
    s_barrier
    s_waitcnt vmcnt(6)
    s_barrier
    s_waitcnt vmcnt(0)
    s_barrier
    s_endpgm
Lp2_c0:
    s_load_dwordx2 s[24:25], s[0:1], 56
    s_load_dwordx2 s[28:29], s[0:1], 72
    s_and_b32 s27, s3, 2
    s_lshl_b32 s23, s50, 6
    s_lshl_b32 s26, s27, 4
    s_add_u32 s23, s23, s26
    v_and_b32 v2, 15, v1
    v_add_u32 v2, s23, v2
    v_lshlrev_b32 v3, 1, v2
    v_lshlrev_b32 v4, 3, v2
    s_and_b32 s22, s3, 1
    s_mul_i32 s22, s22, 2
    v_lshrrev_b32 v5, 2, v1
    v_lshrrev_b32 v6, 1, v5
    v_and_b32 v6, 3, v6
    v_xor_b32 v6, s27, v6
    v_lshlrev_b32 v6, 5, v6
    v_lshl_add_u32 v5, v5, 7, v6
    v_and_b32 v6, 3, v1
    v_lshl_add_u32 v8, v6, 3, v5
    v_xor_b32 v15, 32, v8
    s_lshl_b32 s23, s22, 10
    s_add_u32 s23, s23, 8192
    v_lshl_add_u32 v9, v1, 4, s23
    s_lshl_b32 s23, s27, 10
    v_lshl_add_u32 v13, v1, 3, s23
    v_mul_u32_u24 v12, 1280, v2
    v_lshrrev_b32 v6, 4, v1
    v_lshl_add_u32 v12, v6, 3, v12
    s_add_u32 s23, s22, s51
    s_lshl_b32 s23, s23, 5
    v_add_u32 v12, s23, v12
    v_and_b32 v14, 1, v6
    v_mul_u32_u24 v14, 24, v14
    v_add_u32 v14, v14, v12
    s_waitcnt lgkmcnt(0)
    s_mov_b32 s26, 4096
    s_mov_b32 s27, 0x20000
    s_add_u32 s8, s20, 8388608
    s_addc_u32 s9, s21, 0
    s_mov_b32 s10, 16384
    s_mov_b32 s11, 0x20000
    s_mov_b32 s30, 2621440
    s_mov_b32 s31, 0x20000
    buffer_load_ushort v10, v3, s[24:27], 0 offen
    buffer_load_ushort v11, v3, s[24:27], 0 offen offset:32
    s_setprio 0
    v_mov_b32 v36, 0
    v_mov_b32 v37, 0
    v_mov_b32 v38, 0
    v_mov_b32 v39, 0
    v_mov_b32 v40, 0
    v_mov_b32 v41, 0
    v_mov_b32 v42, 0
    v_mov_b32 v43, 0
    v_mov_b32 v44, 0
    v_mov_b32 v45, 0
    v_mov_b32 v46, 0
    v_mov_b32 v47, 0
    v_mov_b32 v48, 0
    v_mov_b32 v49, 0
    v_mov_b32 v50, 0
    v_mov_b32 v51, 0
    s_mov_b32 s33, 0
    s_mov_b32 s37, 0
    s_barrier
    ds_read_b64 v[52:53], v13 offset:0
    ds_read_b64 v[54:55], v13 offset:512
    ds_read_b128 v[60:63], v9 offset:0
    ds_read_b128 v[64:67], v9 offset:1024
    ds_read_b64 v[56:57], v13 offset:1024
    ds_read_b64 v[58:59], v13 offset:1536
    ds_read_b64 v[68:69], v13 offset:4096
    ds_read_b64 v[70:71], v13 offset:4608
    ds_read_b128 v[76:79], v9 offset:4096
    ds_read_b128 v[80:83], v9 offset:5120
    ds_read_b64 v[72:73], v13 offset:5120
    ds_read_b64 v[74:75], v13 offset:5632
    s_add_u32 s40, s37, 16384
    s_cmp_ge_u32 s40, 131072
    s_cselect_b32 s41, 0, s40
    s_sub_u32 s40, s41, s37
    s_mov_b32 s37, s41
    v_add_u32 v8, s40, v8
    v_add_u32 v15, s40, v15
    v_add_u32 v9, s40, v9
    v_add_u32 v13, s40, v13
.p2align 3
Lp204_ca:
    s_barrier
    ds_read_b64 v[84:85], v13 offset:0
    ds_read_b64 v[86:87], v13 offset:512
    s_waitcnt lgkmcnt(2)
    v_mfma_f32_16x16x32_bf16 v[36:39], v[60:63], v[52:55], v[36:39]
    ds_read_b128 v[92:95], v9 offset:0
    ds_read_b128 v[96:99], v9 offset:1024
    v_mfma_f32_16x16x32_bf16 v[40:43], v[64:67], v[52:55], v[40:43]
    ds_read_b64 v[88:89], v13 offset:1024
    ds_read_b64 v[90:91], v13 offset:1536
    v_mfma_f32_16x16x32_bf16 v[44:47], v[60:63], v[56:59], v[44:47]
    ds_read_b64 v[100:101], v13 offset:4096
    ds_read_b64 v[102:103], v13 offset:4608
    v_mfma_f32_16x16x32_bf16 v[48:51], v[64:67], v[56:59], v[48:51]
    ds_read_b128 v[108:111], v9 offset:4096
    ds_read_b128 v[112:115], v9 offset:5120
    v_mfma_f32_16x16x32_bf16 v[36:39], v[76:79], v[68:71], v[36:39]
    ds_read_b64 v[104:105], v13 offset:5120
    ds_read_b64 v[106:107], v13 offset:5632
    v_mfma_f32_16x16x32_bf16 v[40:43], v[80:83], v[68:71], v[40:43]
    s_add_u32 s40, s37, 16384
    s_cmp_ge_u32 s40, 131072
    v_mfma_f32_16x16x32_bf16 v[44:47], v[76:79], v[72:75], v[44:47]
    s_cselect_b32 s41, 0, s40
    s_sub_u32 s40, s41, s37
    v_mfma_f32_16x16x32_bf16 v[48:51], v[80:83], v[72:75], v[48:51]
    s_mov_b32 s37, s41
    v_add_u32 v8, s40, v8
    v_add_u32 v15, s40, v15
    v_add_u32 v9, s40, v9
    v_add_u32 v13, s40, v13
    s_add_u32 s33, s33, 2
    s_cmp_ge_u32 s33, 10
    s_barrier
    s_cbranch_scc1 Lp204_cax
    ds_read_b64 v[52:53], v13 offset:0
    ds_read_b64 v[54:55], v13 offset:512
    s_waitcnt lgkmcnt(2)
    v_mfma_f32_16x16x32_bf16 v[36:39], v[92:95], v[84:87], v[36:39]
    ds_read_b128 v[60:63], v9 offset:0
    ds_read_b128 v[64:67], v9 offset:1024
    v_mfma_f32_16x16x32_bf16 v[40:43], v[96:99], v[84:87], v[40:43]
    ds_read_b64 v[56:57], v13 offset:1024
    ds_read_b64 v[58:59], v13 offset:1536
    v_mfma_f32_16x16x32_bf16 v[44:47], v[92:95], v[88:91], v[44:47]
    ds_read_b64 v[68:69], v13 offset:4096
    ds_read_b64 v[70:71], v13 offset:4608
    v_mfma_f32_16x16x32_bf16 v[48:51], v[96:99], v[88:91], v[48:51]
    ds_read_b128 v[76:79], v9 offset:4096
    ds_read_b128 v[80:83], v9 offset:5120
    v_mfma_f32_16x16x32_bf16 v[36:39], v[108:111], v[100:103], v[36:39]
    ds_read_b64 v[72:73], v13 offset:5120
    ds_read_b64 v[74:75], v13 offset:5632
    v_mfma_f32_16x16x32_bf16 v[40:43], v[112:115], v[100:103], v[40:43]
    s_add_u32 s40, s37, 16384
    s_cmp_ge_u32 s40, 131072
    v_mfma_f32_16x16x32_bf16 v[44:47], v[108:111], v[104:107], v[44:47]
    s_cselect_b32 s41, 0, s40
    s_sub_u32 s40, s41, s37
    v_mfma_f32_16x16x32_bf16 v[48:51], v[112:115], v[104:107], v[48:51]
    s_mov_b32 s37, s41
    v_add_u32 v8, s40, v8
    v_add_u32 v15, s40, v15
    v_add_u32 v9, s40, v9
    v_add_u32 v13, s40, v13
    s_branch Lp204_ca
Lp204_cax:
    ds_read_b64_tr_b16 v[52:53], v8 offset:0
    ds_read_b64_tr_b16 v[54:55], v8 offset:2048
    s_waitcnt lgkmcnt(2)
    v_mfma_f32_16x16x32_bf16 v[36:39], v[92:95], v[84:87], v[36:39]
    ds_read_b128 v[60:63], v9 offset:0
    ds_read_b128 v[64:67], v9 offset:1024
    v_mfma_f32_16x16x32_bf16 v[40:43], v[96:99], v[84:87], v[40:43]
    ds_read_b64_tr_b16 v[56:57], v15 offset:0
    ds_read_b64_tr_b16 v[58:59], v15 offset:2048
    v_mfma_f32_16x16x32_bf16 v[44:47], v[92:95], v[88:91], v[44:47]
    ds_read_b64_tr_b16 v[68:69], v8 offset:4096
    ds_read_b64_tr_b16 v[70:71], v8 offset:6144
    v_mfma_f32_16x16x32_bf16 v[48:51], v[96:99], v[88:91], v[48:51]
    ds_read_b128 v[76:79], v9 offset:4096
    ds_read_b128 v[80:83], v9 offset:5120
    v_mfma_f32_16x16x32_bf16 v[36:39], v[108:111], v[100:103], v[36:39]
    ds_read_b64_tr_b16 v[72:73], v15 offset:4096
    ds_read_b64_tr_b16 v[74:75], v15 offset:6144
    v_mfma_f32_16x16x32_bf16 v[40:43], v[112:115], v[100:103], v[40:43]
    s_add_u32 s40, s37, 16384
    s_cmp_ge_u32 s40, 131072
    v_mfma_f32_16x16x32_bf16 v[44:47], v[108:111], v[104:107], v[44:47]
    s_cselect_b32 s41, 0, s40
    s_sub_u32 s40, s41, s37
    v_mfma_f32_16x16x32_bf16 v[48:51], v[112:115], v[104:107], v[48:51]
    s_mov_b32 s37, s41
    v_add_u32 v8, s40, v8
    v_add_u32 v15, s40, v15
    v_add_u32 v9, s40, v9
    s_waitcnt vmcnt(0)
    buffer_load_dwordx2 v[16:17], v4, s[8:11], 0 offen sc1
    buffer_load_dwordx2 v[18:19], v4, s[8:11], 0 offen offset:128 sc1
    v_lshlrev_b32 v10, 16, v10
    v_lshlrev_b32 v11, 16, v11
    v_mov_b32 v20, v10
    v_mov_b32 v21, v10
    v_mov_b32 v22, v10
    v_mov_b32 v23, v10
    v_mov_b32 v24, v10
    v_mov_b32 v25, v10
    v_mov_b32 v26, v10
    v_mov_b32 v27, v10
    v_mov_b32 v28, v11
    v_mov_b32 v29, v11
    v_mov_b32 v30, v11
    v_mov_b32 v31, v11
    v_mov_b32 v32, v11
    v_mov_b32 v33, v11
    v_mov_b32 v34, v11
    v_mov_b32 v35, v11
.p2align 3
Lp204_cb:
    s_barrier
    ds_read_b64_tr_b16 v[84:85], v8 offset:0
    ds_read_b64_tr_b16 v[86:87], v8 offset:2048
    s_waitcnt lgkmcnt(2)
    v_mfma_f32_16x16x32_bf16 v[20:23], v[60:63], v[52:55], v[20:23]
    ds_read_b128 v[92:95], v9 offset:0
    ds_read_b128 v[96:99], v9 offset:1024
    v_mfma_f32_16x16x32_bf16 v[24:27], v[64:67], v[52:55], v[24:27]
    ds_read_b64_tr_b16 v[88:89], v15 offset:0
    ds_read_b64_tr_b16 v[90:91], v15 offset:2048
    v_mfma_f32_16x16x32_bf16 v[28:31], v[60:63], v[56:59], v[28:31]
    ds_read_b64_tr_b16 v[100:101], v8 offset:4096
    ds_read_b64_tr_b16 v[102:103], v8 offset:6144
    v_mfma_f32_16x16x32_bf16 v[32:35], v[64:67], v[56:59], v[32:35]
    ds_read_b128 v[108:111], v9 offset:4096
    ds_read_b128 v[112:115], v9 offset:5120
    v_mfma_f32_16x16x32_bf16 v[20:23], v[76:79], v[68:71], v[20:23]
    ds_read_b64_tr_b16 v[104:105], v15 offset:4096
    ds_read_b64_tr_b16 v[106:107], v15 offset:6144
    v_mfma_f32_16x16x32_bf16 v[24:27], v[80:83], v[68:71], v[24:27]
    s_add_u32 s40, s37, 16384
    s_cmp_ge_u32 s40, 131072
    v_mfma_f32_16x16x32_bf16 v[28:31], v[76:79], v[72:75], v[28:31]
    s_cselect_b32 s41, 0, s40
    s_sub_u32 s40, s41, s37
    v_mfma_f32_16x16x32_bf16 v[32:35], v[80:83], v[72:75], v[32:35]
    s_mov_b32 s37, s41
    v_add_u32 v8, s40, v8
    v_add_u32 v15, s40, v15
    v_add_u32 v9, s40, v9
    s_add_u32 s33, s33, 2
    s_cmp_ge_u32 s33, 34
    s_cbranch_scc1 Lp204_clast
    s_barrier
    ds_read_b64_tr_b16 v[52:53], v8 offset:0
    ds_read_b64_tr_b16 v[54:55], v8 offset:2048
    s_waitcnt lgkmcnt(2)
    v_mfma_f32_16x16x32_bf16 v[20:23], v[92:95], v[84:87], v[20:23]
    ds_read_b128 v[60:63], v9 offset:0
    ds_read_b128 v[64:67], v9 offset:1024
    v_mfma_f32_16x16x32_bf16 v[24:27], v[96:99], v[84:87], v[24:27]
    ds_read_b64_tr_b16 v[56:57], v15 offset:0
    ds_read_b64_tr_b16 v[58:59], v15 offset:2048
    v_mfma_f32_16x16x32_bf16 v[28:31], v[92:95], v[88:91], v[28:31]
    ds_read_b64_tr_b16 v[68:69], v8 offset:4096
    ds_read_b64_tr_b16 v[70:71], v8 offset:6144
    v_mfma_f32_16x16x32_bf16 v[32:35], v[96:99], v[88:91], v[32:35]
    ds_read_b128 v[76:79], v9 offset:4096
    ds_read_b128 v[80:83], v9 offset:5120
    v_mfma_f32_16x16x32_bf16 v[20:23], v[108:111], v[100:103], v[20:23]
    ds_read_b64_tr_b16 v[72:73], v15 offset:4096
    ds_read_b64_tr_b16 v[74:75], v15 offset:6144
    v_mfma_f32_16x16x32_bf16 v[24:27], v[112:115], v[100:103], v[24:27]
    s_add_u32 s40, s37, 16384
    s_cmp_ge_u32 s40, 131072
    v_mfma_f32_16x16x32_bf16 v[28:31], v[108:111], v[104:107], v[28:31]
    s_cselect_b32 s41, 0, s40
    s_sub_u32 s40, s41, s37
    v_mfma_f32_16x16x32_bf16 v[32:35], v[112:115], v[104:107], v[32:35]
    s_mov_b32 s37, s41
    v_add_u32 v8, s40, v8
    v_add_u32 v15, s40, v15
    v_add_u32 v9, s40, v9
    s_branch Lp204_cb
Lp204_clast:
    s_waitcnt lgkmcnt(9)
    v_mfma_f32_16x16x32_bf16 v[20:23], v[92:95], v[84:87], v[20:23]
    s_waitcnt lgkmcnt(8)
    v_mfma_f32_16x16x32_bf16 v[24:27], v[96:99], v[84:87], v[24:27]
    s_waitcnt lgkmcnt(6)
    v_mfma_f32_16x16x32_bf16 v[28:31], v[92:95], v[88:91], v[28:31]
    v_mfma_f32_16x16x32_bf16 v[32:35], v[96:99], v[88:91], v[32:35]
    s_waitcnt lgkmcnt(3)
    v_mfma_f32_16x16x32_bf16 v[20:23], v[108:111], v[100:103], v[20:23]
    s_waitcnt lgkmcnt(2)
    v_mfma_f32_16x16x32_bf16 v[24:27], v[112:115], v[100:103], v[24:27]
    s_waitcnt lgkmcnt(0)
    v_mfma_f32_16x16x32_bf16 v[28:31], v[108:111], v[104:107], v[28:31]
    v_mfma_f32_16x16x32_bf16 v[32:35], v[112:115], v[104:107], v[32:35]
    s_mov_b32 s49, 0
    s_mov_b32 s22, 20480
Lp204_g:
    s_waitcnt vmcnt(0)
    v_cmp_ne_u32 vcc, s48, v17
    v_cmp_ne_u32 s[26:27], s48, v19
    s_add_u32 s49, s49, 1
    s_or_b64 vcc, vcc, s[26:27]
    s_cbranch_scc0 Lp204_gk
    buffer_load_dwordx2 v[16:17], v4, s[8:11], 0 offen sc1
    buffer_load_dwordx2 v[18:19], v4, s[8:11], 0 offen offset:128 sc1
    s_cmp_lt_u32 s49, 20000
    s_cbranch_scc1 Lp204_g
    s_waitcnt vmcnt(0)
Lp204_gk:
    v_pk_add_f32 v[36:37], v[36:37], v[20:21] neg_lo:[0,1] neg_hi:[0,1]
    v_pk_add_f32 v[38:39], v[38:39], v[22:23] neg_lo:[0,1] neg_hi:[0,1]
    v_pk_fma_f32 v[20:21], v[36:37], v[16:17], v[20:21] op_sel_hi:[1,0,1]
    v_pk_fma_f32 v[22:23], v[38:39], v[16:17], v[22:23] op_sel_hi:[1,0,1]
    v_cvt_pk_bf16_f32 v52, v20, v21
    v_cvt_pk_bf16_f32 v53, v22, v23
    v_pk_add_f32 v[40:41], v[40:41], v[24:25] neg_lo:[0,1] neg_hi:[0,1]
    v_pk_add_f32 v[42:43], v[42:43], v[26:27] neg_lo:[0,1] neg_hi:[0,1]
    v_pk_fma_f32 v[24:25], v[40:41], v[16:17], v[24:25] op_sel_hi:[1,0,1]
    v_pk_fma_f32 v[26:27], v[42:43], v[16:17], v[26:27] op_sel_hi:[1,0,1]
    v_cvt_pk_bf16_f32 v54, v24, v25
    v_cvt_pk_bf16_f32 v55, v26, v27
    s_nop 0
    v_permlane16_swap_b32 v52, v54
    v_permlane16_swap_b32 v53, v55
    buffer_store_dwordx4 v[52:55], v14, s[28:31], 0 offen
    v_pk_add_f32 v[44:45], v[44:45], v[28:29] neg_lo:[0,1] neg_hi:[0,1]
    v_pk_add_f32 v[46:47], v[46:47], v[30:31] neg_lo:[0,1] neg_hi:[0,1]
    v_pk_fma_f32 v[28:29], v[44:45], v[18:19], v[28:29] op_sel_hi:[1,0,1]
    v_pk_fma_f32 v[30:31], v[46:47], v[18:19], v[30:31] op_sel_hi:[1,0,1]
    v_cvt_pk_bf16_f32 v60, v28, v29
    v_cvt_pk_bf16_f32 v61, v30, v31
    v_pk_add_f32 v[48:49], v[48:49], v[32:33] neg_lo:[0,1] neg_hi:[0,1]
    v_pk_add_f32 v[50:51], v[50:51], v[34:35] neg_lo:[0,1] neg_hi:[0,1]
    v_pk_fma_f32 v[32:33], v[48:49], v[18:19], v[32:33] op_sel_hi:[1,0,1]
    v_pk_fma_f32 v[34:35], v[50:51], v[18:19], v[34:35] op_sel_hi:[1,0,1]
    v_cvt_pk_bf16_f32 v62, v32, v33
    v_cvt_pk_bf16_f32 v63, v34, v35
    s_nop 0
    v_permlane16_swap_b32 v60, v62
    v_permlane16_swap_b32 v61, v63
    buffer_store_dwordx4 v[60:63], v14, s[28:31], s22 offen
    s_endpgm
Lp2_s0:
    s_load_dwordx2 s[12:13], s[0:1], 48
    v_lshrrev_b32 v2, 3, v1
    v_and_b32 v3, 7, v1
    v_and_b32 v4, 6, v2
    v_xor_b32 v3, v3, v4
    v_lshlrev_b32 v3, 4, v3
    v_lshl_add_u32 v2, v2, 12, v3
    s_lshl_b32 s23, s3, 17
    s_lshl_b32 s26, s50, 7
    s_add_u32 s23, s23, s26
    v_add_u32 v8, s23, v2
    v_add_u32 v9, 32768, v8
    v_add_u32 v10, 65536, v8
    v_add_u32 v11, 98304, v8
    s_lshl_b32 s23, s50, 2
    s_mul_i32 s23, s23, 40
    s_lshl_b32 s26, s3, 1
    s_add_u32 s23, s23, s26
    s_lshl_b32 s23, s23, 9
    v_lshl_add_u32 v16, v1, 4, s23
    v_add_u32 v17, 20480, v16
    v_add_u32 v18, 40960, v16
    v_add_u32 v19, 61440, v16
    s_and_b32 s23, s50, -2
    s_add_u32 s23, s23, 0
    s_lshl_b32 s23, s23, 10
    s_add_u32 s23, s23, 131072
    v_lshl_add_u32 v12, v1, 7, s23
    s_mov_b32 s34, 0
    s_lshl_b32 s37, s3, 12
    s_add_u32 s38, s37, 131072
    s_mov_b32 s33, 0
    s_waitcnt lgkmcnt(0)
    s_add_u32 s4, s20, 2621440
    s_addc_u32 s5, s21, 0
    s_mov_b32 s6, 2621440
    s_mov_b32 s7, 0x20000
Lp2_s04e:
    s_barrier
    s_mov_b32 s49, 0
    s_mov_b32 exec_lo, 255
    s_mov_b32 exec_hi, 0
Lg28:
    buffer_load_dword v2, v12, s[44:47], 0 offen sc1
    s_waitcnt vmcnt(0)
    v_xor_b32 v2, s48, v2
    v_cmp_ne_u32 vcc, 0, v2
    s_add_u32 s49, s49, 1
    s_cmp_eq_u64 vcc, 0
    s_cbranch_scc1 Lg28d
    s_sleep 2
    s_cmp_lt_u32 s49, 20000
    s_cbranch_scc1 Lg28
Lg28d:
    s_mov_b64 exec, -1
Lp2_s04k:
    s_add_u32 s32, s33, 6
Li29:
    s_lshl_b32 s40, s34, 11
    s_add_u32 m0, s37, 0
    s_nop 0
    buffer_load_dwordx4 v16, s[4:7], s40 offen sc1 lds
    s_add_u32 m0, s37, 1024
    s_nop 0
    buffer_load_dwordx4 v17, s[4:7], s40 offen sc1 lds
    s_add_u32 m0, s37, 2048
    s_nop 0
    buffer_load_dwordx4 v18, s[4:7], s40 offen sc1 lds
    s_add_u32 m0, s37, 3072
    s_nop 0
    buffer_load_dwordx4 v19, s[4:7], s40 offen sc1 lds
    s_add_u32 s37, s37, 16384
    s_cmp_ge_u32 s37, s38
    s_cselect_b32 s42, 131072, 0
    s_sub_u32 s37, s37, s42
    s_add_u32 s34, s34, 1
    s_add_u32 s33, s33, 1
    s_cmp_lt_u32 s33, s32
    s_cbranch_scc1 Li29
Ls30:
    s_waitcnt vmcnt(20)
    s_barrier
    s_lshl_b32 s40, s34, 11
    s_add_u32 m0, s37, 0
    s_nop 0
    buffer_load_dwordx4 v16, s[4:7], s40 offen sc1 lds
    s_add_u32 m0, s37, 1024
    s_nop 0
    buffer_load_dwordx4 v17, s[4:7], s40 offen sc1 lds
    s_add_u32 m0, s37, 2048
    s_nop 0
    buffer_load_dwordx4 v18, s[4:7], s40 offen sc1 lds
    s_add_u32 m0, s37, 3072
    s_nop 0
    buffer_load_dwordx4 v19, s[4:7], s40 offen sc1 lds
    s_add_u32 s37, s37, 16384
    s_cmp_ge_u32 s37, s38
    s_cselect_b32 s42, 131072, 0
    s_sub_u32 s37, s37, s42
    s_add_u32 s34, s34, 1
    s_add_u32 s33, s33, 1
    s_cmp_lt_u32 s33, 10
    s_cbranch_scc1 Ls30
    s_mov_b32 s4, s12
    s_mov_b32 s5, s13
    s_mov_b32 s6, 6291456
    s_mov_b32 s7, 0x20000
    s_mov_b32 s34, 0
Ls31:
    s_waitcnt vmcnt(20)
    s_barrier
    s_lshl_b32 s40, s34, 18
    s_add_u32 m0, s37, 0
    s_nop 0
    buffer_load_dwordx4 v8, s[4:7], s40 offen  lds
    s_add_u32 m0, s37, 1024
    s_nop 0
    buffer_load_dwordx4 v9, s[4:7], s40 offen  lds
    s_add_u32 m0, s37, 2048
    s_nop 0
    buffer_load_dwordx4 v10, s[4:7], s40 offen  lds
    s_add_u32 m0, s37, 3072
    s_nop 0
    buffer_load_dwordx4 v11, s[4:7], s40 offen  lds
    s_add_u32 s37, s37, 16384
    s_cmp_ge_u32 s37, s38
    s_cselect_b32 s42, 131072, 0
    s_sub_u32 s37, s37, s42
    s_add_u32 s34, s34, 1
    s_add_u32 s33, s33, 1
    s_cmp_lt_u32 s33, 34
    s_cbranch_scc1 Ls31
    s_waitcnt vmcnt(20)
    s_barrier
    s_waitcnt vmcnt(16)
    s_barrier
    s_waitcnt vmcnt(12)
    s_barrier
    s_waitcnt vmcnt(8)
    s_barrier
    s_waitcnt vmcnt(4)
    s_barrier
    s_waitcnt vmcnt(0)
    s_barrier
    s_endpgm
Lp2_d0:
    s_sub_u32 s22, s3, 2
    s_mul_i32 s23, s51, 68
    s_add_u32 s23, s23, s22
    s_lshl_b32 s23, s23, 10
    v_lshl_add_u32 v8, v1, 4, s23
    v_add_u32 v9, 69632, v8
    v_add_u32 v10, 139264, v8
    v_add_u32 v11, 208896, v8
    s_mul_i32 s37, s22, 4096
    s_add_u32 s37, s37, 8192
    s_add_u32 s38, s37, 131072
    s_lshl_b32 s23, s52, 10
    s_add_u32 s23, s23, 327680
    v_lshl_add_u32 v16, v1, 7, s23
    s_lshr_b32 s23, s51, 2
    s_lshl_b32 s23, s23, 11
    s_lshr_b32 s26, s52, 1
    s_mul_i32 s26, s26, 20480
    s_add_u32 s23, s23, s26
    s_add_u32 s23, s23, 163840
    v_lshl_add_u32 v17, v1, 7, s23
    s_mov_b32 s34, 0
    s_mov_b32 s36, 48
    s_mov_b32 s33, 0
    s_add_u32 s8, s20, 5242880
    s_addc_u32 s9, s21, 0
    s_mov_b32 s10, 2785280
    s_mov_b32 s11, 0x20000
Lp2_d04e:
    s_barrier
    s_mov_b32 s49, 0
    s_mov_b32 exec_lo, 255
    s_mov_b32 exec_hi, 0
Lg32:
    buffer_load_dword v2, v16, s[44:47], 0 offen sc1
    s_waitcnt vmcnt(0)
    v_xor_b32 v2, s48, v2
    v_cmp_ne_u32 vcc, 0, v2
    s_add_u32 s49, s49, 1
    s_cmp_eq_u64 vcc, 0
    s_cbranch_scc1 Lg32d
    s_sleep 8
    s_cmp_lt_u32 s49, 20000
    s_cbranch_scc1 Lg32
Lg32d:
    s_mov_b64 exec, -1
Lp2_d04k:
    s_add_u32 s32, s33, 6
Li33:
    s_lshl_b32 s41, s34, 1
    s_add_u32 s41, s41, s36
    s_lshl_b32 s41, s41, 10
    s_add_u32 m0, s37, 0
    s_nop 0
    buffer_load_dwordx4 v8, s[8:11], s41 offen sc1 lds
    s_add_u32 m0, s37, 1024
    s_nop 0
    buffer_load_dwordx4 v9, s[8:11], s41 offen sc1 lds
    s_add_u32 m0, s37, 2048
    s_nop 0
    buffer_load_dwordx4 v10, s[8:11], s41 offen sc1 lds
    s_add_u32 m0, s37, 3072
    s_nop 0
    buffer_load_dwordx4 v11, s[8:11], s41 offen sc1 lds
    s_add_u32 s37, s37, 16384
    s_cmp_ge_u32 s37, s38
    s_cselect_b32 s42, 131072, 0
    s_sub_u32 s37, s37, s42
    s_add_u32 s34, s34, 1
    s_add_u32 s33, s33, 1
    s_cmp_lt_u32 s33, s32
    s_cbranch_scc1 Li33
Ls34:
    s_waitcnt vmcnt(20)
    s_barrier
    s_lshl_b32 s41, s34, 1
    s_add_u32 s41, s41, s36
    s_lshl_b32 s41, s41, 10
    s_add_u32 m0, s37, 0
    s_nop 0
    buffer_load_dwordx4 v8, s[8:11], s41 offen sc1 lds
    s_add_u32 m0, s37, 1024
    s_nop 0
    buffer_load_dwordx4 v9, s[8:11], s41 offen sc1 lds
    s_add_u32 m0, s37, 2048
    s_nop 0
    buffer_load_dwordx4 v10, s[8:11], s41 offen sc1 lds
    s_add_u32 m0, s37, 3072
    s_nop 0
    buffer_load_dwordx4 v11, s[8:11], s41 offen sc1 lds
    s_add_u32 s37, s37, 16384
    s_cmp_ge_u32 s37, s38
    s_cselect_b32 s42, 131072, 0
    s_sub_u32 s37, s37, s42
    s_add_u32 s34, s34, 1
    s_add_u32 s33, s33, 1
    s_cmp_lt_u32 s33, 10
    s_cbranch_scc1 Ls34
    s_waitcnt vmcnt(20)
    s_barrier
    s_waitcnt vmcnt(16)
    s_barrier
    s_waitcnt vmcnt(12)
    s_barrier
    s_mov_b32 s36, 0
    s_mov_b32 s34, 0
    s_mov_b32 s49, 0
    s_mov_b32 exec_lo, 4095
    s_mov_b32 exec_hi, 0
Lg35:
    buffer_load_dword v2, v17, s[44:47], 0 offen sc1
    s_waitcnt vmcnt(0)
    v_xor_b32 v2, s48, v2
    v_cmp_ne_u32 vcc, 0, v2
    s_add_u32 s49, s49, 1
    s_cmp_eq_u64 vcc, 0
    s_cbranch_scc1 Lg35d
    s_sleep 2
    s_cmp_lt_u32 s49, 20000
    s_cbranch_scc1 Lg35
Lg35d:
    s_mov_b64 exec, -1
    s_add_u32 s32, s33, 3
Li36:
    s_lshl_b32 s41, s34, 1
    s_add_u32 s41, s41, s36
    s_lshl_b32 s41, s41, 10
    s_add_u32 m0, s37, 0
    s_nop 0
    buffer_load_dwordx4 v8, s[8:11], s41 offen sc1 lds
    s_add_u32 m0, s37, 1024
    s_nop 0
    buffer_load_dwordx4 v9, s[8:11], s41 offen sc1 lds
    s_add_u32 m0, s37, 2048
    s_nop 0
    buffer_load_dwordx4 v10, s[8:11], s41 offen sc1 lds
    s_add_u32 m0, s37, 3072
    s_nop 0
    buffer_load_dwordx4 v11, s[8:11], s41 offen sc1 lds
    s_add_u32 s37, s37, 16384
    s_cmp_ge_u32 s37, s38
    s_cselect_b32 s42, 131072, 0
    s_sub_u32 s37, s37, s42
    s_add_u32 s34, s34, 1
    s_add_u32 s33, s33, 1
    s_cmp_lt_u32 s33, s32
    s_cbranch_scc1 Li36
Ls37:
    s_waitcnt vmcnt(20)
    s_barrier
    s_lshl_b32 s41, s34, 1
    s_add_u32 s41, s41, s36
    s_lshl_b32 s41, s41, 10
    s_add_u32 m0, s37, 0
    s_nop 0
    buffer_load_dwordx4 v8, s[8:11], s41 offen sc1 lds
    s_add_u32 m0, s37, 1024
    s_nop 0
    buffer_load_dwordx4 v9, s[8:11], s41 offen sc1 lds
    s_add_u32 m0, s37, 2048
    s_nop 0
    buffer_load_dwordx4 v10, s[8:11], s41 offen sc1 lds
    s_add_u32 m0, s37, 3072
    s_nop 0
    buffer_load_dwordx4 v11, s[8:11], s41 offen sc1 lds
    s_add_u32 s37, s37, 16384
    s_cmp_ge_u32 s37, s38
    s_cselect_b32 s42, 131072, 0
    s_sub_u32 s37, s37, s42
    s_add_u32 s34, s34, 1
    s_add_u32 s33, s33, 1
    s_cmp_lt_u32 s33, 34
    s_cbranch_scc1 Ls37
    s_waitcnt vmcnt(20)
    s_barrier
    s_waitcnt vmcnt(16)
    s_barrier
    s_waitcnt vmcnt(12)
    s_barrier
    s_waitcnt vmcnt(8)
    s_barrier
    s_waitcnt vmcnt(4)
    s_barrier
    s_waitcnt vmcnt(0)
    s_barrier
    s_endpgm
Lend:
    s_endpgm
Lcode_end:
.section .rodata,"a"
.p2align 6
.amdhsa_kernel gated_mix__sliding_local_dilated__mixer_token_mlp__prompt_kernel
  .amdhsa_next_free_vgpr 256
  .amdhsa_next_free_sgpr 102
  .amdhsa_accum_offset 256
  .amdhsa_group_segment_fixed_size 0
  .amdhsa_kernarg_size 96
  .amdhsa_user_sgpr_count 2
  .amdhsa_user_sgpr_kernarg_segment_ptr 1
  .amdhsa_system_sgpr_workgroup_id_x 1
  .amdhsa_float_denorm_mode_32 3
.end_amdhsa_kernel
```
